```python
import torch

def _softmax(x, axis=-1):
    return torch.softmax(x, dim=axis)
def _gelu(x):
    return torch.nn.functional.gelu(x, approximate="tanh")
def _silu(x):
    return torch.nn.functional.silu(x)
def _sigmoid(x):
    return torch.sigmoid(x)
def _layernorm(x, axis=-1, eps=1e-5):
    m = x.mean(dim=axis, keepdim=True)
    v = x.var(dim=axis, keepdim=True, unbiased=False)
    return (x - m) / torch.sqrt(v + eps)
def _scatter_add(tgt, idx, src, axis=0):
    return tgt.clone().index_add_(axis, idx, src)
def _segment_sum(src, seg, n):
    out = torch.zeros((n,) + src.shape[1:], dtype=src.dtype)
    return out.index_add_(0, seg, src)
def _pad(x, pw):
    flat = tuple(v for pair in reversed(pw) for v in pair)
    return torch.nn.functional.pad(x, flat)

kernel_name = 'standalone__sliding_block_cached__sampling'

def setup_inputs():

    _w = (lambda a: (lambda t: t.to(torch.bfloat16) if t.is_floating_point() else t)(torch.as_tensor(a)))
    B, Sq, D = 8, 32, 1024
    Hq, Hkv, Sk, Dh = 32, 4, 8192, 128
    assert Hq % Hkv == 0, (Hq, Hkv)
    return {
        "x": _w((lambda *s: torch.randn(*s, dtype=torch.bfloat16) * 0.8)(B, Sq, D)),
        "k_cache": _w((lambda *s: torch.randn(*s, dtype=torch.bfloat16) * 0.8)(B, Hkv, Sk, Dh)),
        "v_cache": _w((lambda *s: torch.randn(*s, dtype=torch.bfloat16) * 0.05)(B, Hkv, Sk, Dh)),
        "wq": _w((lambda *s: torch.randn(*s, dtype=torch.bfloat16) * 0.8)(D, Hq * Dh) * (D ** -0.5)),
        "wo": _w((lambda *s: torch.randn(*s, dtype=torch.bfloat16) * 0.05)(Hq * Dh, D) * ((Hq * Dh) ** -0.5)),
    }

def reference(x, k_cache, v_cache, wq, wo):
    B, Sq, D = x.shape
    Hq, Dh = 32, 128
    Hkv, Sk = k_cache.shape[1], k_cache.shape[2]
    W = min(4096, max(256, Sk // 4))
    rep = Hq // Hkv
    q = (lambda x, *d: x.permute(*d))((x @ wq).reshape(B, Sq, Hq, Dh), 0, 2, 1, 3)
    k = (lambda x, n, axis: torch.repeat_interleave(x, n, dim=axis))(k_cache[:, :, Sk - W:, :], rep, axis=1)
    v = (lambda x, n, axis: torch.repeat_interleave(x, n, dim=axis))(v_cache[:, :, Sk - W:, :], rep, axis=1)
    scores = torch.einsum("bhqd,bhkd->bhqk", q, k) * (Dh ** -0.5)
    p = _softmax(scores, axis=-1)
    o = torch.einsum("bhqk,bhkd->bhqd", p, v)
    return (lambda x, *d: x.permute(*d))(o, 0, 2, 1, 3).reshape(B, Sq, Hq * Dh) @ wo
```

```asm
; @launch grid=(256,1,1) block=(512,1,1) lds=163840
.amdgcn_target "amdgcn-amd-amdhsa--gfx950"
.text
.globl standalone__sliding_block_cached__sampling_kernel
.p2align 8
.type standalone__sliding_block_cached__sampling_kernel,@function
standalone__sliding_block_cached__sampling_kernel:
    s_cmp_ge_u32 s2, 256
    s_cbranch_scc1 L_exit
    s_load_dwordx16 s[4:19], s[0:1], 0
    s_memrealtime s[62:63]
    v_and_b32 v1, 63, v0
    v_lshrrev_b32 v8, 6, v0
    v_mov_b32 v7, 0
    v_readfirstlane_b32 s52, v8
    s_and_b32 s72, s2, 7
    s_lshr_b32 s73, s2, 3
    s_and_b32 s53, s73, 7
    s_lshl_b32 s74, s72, 3
    s_add_u32 s53, s53, s74
    s_lshr_b32 s54, s73, 3
    v_lshrrev_b32 v13, 4, v1
    v_and_b32 v14, 15, v1
    v_xor_b32 v15, v13, v14
    v_lshlrev_b32 v15, 4, v15
    v_lshlrev_b32 v6, 2, v13
    v_xor_b32 v6, v6, v14
    v_lshlrev_b32 v6, 4, v6
    s_and_b32 s71, s52, 3
    v_and_b32 v16, 1, v13
    v_lshlrev_b32 v16, 2, v16
    v_and_b32 v17, 7, v1
    v_xor_b32 v16, v16, v17
    v_lshlrev_b32 v16, 4, v16
    v_lshrrev_b32 v17, 3, v1
    v_lshl_add_u32 v16, v17, 13, v16
    v_add_u32 v17, 64512, v16
    v_add_u32 v18, 129024, v16
    v_add_u32 v19, 193536, v16
    v_lshl_add_u32 v20, v13, 11, v15
    v_xor_b32 v21, 64, v20
    v_add_u32 v21, 7168, v21
    v_xor_b32 v22, 128, v20
    v_add_u32 v22, 14336, v22
    v_xor_b32 v23, 192, v20
    v_add_u32 v23, 21504, v23
    s_lshl_b32 s75, s71, 7
    s_and_b32 s75, s75, 0xc0
    v_xor_b32 v15, s75, v15
    v_lshlrev_b32 v27, 7, v1
    s_lshl_b32 s80, s53, 7
    s_lshl_b32 s75, s71, 18
    s_add_u32 s80, s80, s75
    s_lshl_b32 s81, s54, 17
    s_lshl_b32 s75, s71, 15
    s_add_u32 s81, s81, s75
    s_lshl_b32 s83, s71, 11
    s_lshl_b32 s79, s71, 12
    s_lshl_b32 s78, s54, 1
    s_add_u32 s78, s78, s72
    s_waitcnt lgkmcnt(0)
    s_mov_b32 s20, s4
    s_mov_b32 s21, s5
    s_mov_b32 s22, 0x80000
    s_mov_b32 s23, 0x20000
    s_mov_b32 s32, s10
    s_mov_b32 s33, s11
    s_mov_b32 s34, 0x800000
    s_mov_b32 s35, 0x20000
    s_cmp_lt_u32 s52, 4
    s_cbranch_scc1 L_nostart
    s_add_u32 s76, s78, 0
    s_and_b32 s76, s76, 7
    s_lshl_b32 s77, s76, 8
    s_add_u32 s77, s77, s81
    s_add_u32 m0, s79, 0
    s_lshl_b32 s76, s76, 20
    s_add_u32 s76, s76, s80
    buffer_load_dwordx4 v16, s[32:35], s76 offen offset:0 lds
    buffer_load_dwordx4 v17, s[32:35], s76 offen offset:1024 lds
    buffer_load_dwordx4 v18, s[32:35], s76 offen offset:2048 lds
    buffer_load_dwordx4 v19, s[32:35], s76 offen offset:3072 lds
    s_add_u32 m0, s79, 16384
    s_nop 0
    buffer_load_dwordx4 v20, s[20:23], s77 offen offset:0 lds
    buffer_load_dwordx4 v21, s[20:23], s77 offen offset:1024 lds
    buffer_load_dwordx4 v22, s[20:23], s77 offen offset:2048 lds
    buffer_load_dwordx4 v23, s[20:23], s77 offen offset:3072 lds
    s_add_u32 s76, s78, 1
    s_and_b32 s76, s76, 7
    s_lshl_b32 s77, s76, 8
    s_add_u32 s77, s77, s81
    s_add_u32 m0, s79, 40960
    s_lshl_b32 s76, s76, 20
    s_add_u32 s76, s76, s80
    buffer_load_dwordx4 v16, s[32:35], s76 offen offset:0 lds
    buffer_load_dwordx4 v17, s[32:35], s76 offen offset:1024 lds
    buffer_load_dwordx4 v18, s[32:35], s76 offen offset:2048 lds
    buffer_load_dwordx4 v19, s[32:35], s76 offen offset:3072 lds
    s_add_u32 m0, s79, 57344
    s_nop 0
    buffer_load_dwordx4 v20, s[20:23], s77 offen offset:0 lds
    buffer_load_dwordx4 v21, s[20:23], s77 offen offset:1024 lds
    buffer_load_dwordx4 v22, s[20:23], s77 offen offset:2048 lds
    buffer_load_dwordx4 v23, s[20:23], s77 offen offset:3072 lds
    s_branch L_started
L_nostart:
L_started:
    s_mov_b32 s24, s6
    s_mov_b32 s25, s7
    s_mov_b32 s26, 0x4000000
    s_mov_b32 s27, 0x20000
    s_mov_b32 s28, s8
    s_mov_b32 s29, s9
    s_mov_b32 s30, 0x4000000
    s_mov_b32 s31, 0x20000
    s_mov_b32 s36, s12
    s_mov_b32 s37, s13
    s_mov_b32 s38, 0x800000
    s_mov_b32 s39, 0x20000
    s_mov_b32 s40, s14
    s_mov_b32 s41, s15
    s_mov_b32 s42, 0x80000
    s_mov_b32 s43, 0x20000
    s_mov_b32 s44, s16
    s_mov_b32 s45, s17
    s_mov_b32 s46, 0x100
    s_mov_b32 s47, 0x20000
    s_mov_b32 s48, s18
    s_mov_b32 s49, s19
    s_mov_b32 s50, 0x10000000
    s_mov_b32 s51, 0x20000
    s_or_b32 s75, s2, s52
    s_cmp_lg_u32 s75, 0
    s_cbranch_scc1 L_notag
    s_or_b32 s75, s62, 1
    v_mov_b32 v28, s75
    v_mov_b32 v29, s63
    v_mov_b32 v30, 0
    s_mov_b64 exec, 1
    buffer_store_dwordx2 v[28:29], v30, s[44:47], 0 offen sc1
    s_mov_b64 exec, -1
L_notag:
    s_lshr_b32 s60, s73, 3
    s_and_b32 s55, s72, 1
    s_lshl_b32 s55, s55, 2
    s_add_u32 s55, s55, s60
    s_lshr_b32 s56, s72, 1
    s_bfe_u32 s57, s73, 0x10002
    s_and_b32 s58, s73, 3
    s_and_b32 s59, s72, 1
    s_lshl_b32 s59, s59, 2
    s_add_u32 s59, s59, s58
    s_lshr_b32 s60, s73, 2
    s_mov_b32 s66, 0x3e0293ee
    s_mov_b32 s67, 0x41000000
    s_mov_b32 s68, 0
    s_mov_b32 s69, 0x05040100
    s_mov_b32 s70, 0x07060302
    v_lshl_add_u32 v2, v13, 8, v15
    v_xor_b32 v3, 64, v2
    v_lshl_add_u32 v6, v13, 8, v6
    s_lshl_b32 s61, s55, 2
    s_add_u32 s61, s61, s56
    s_lshl_b32 s61, s61, 21
    s_add_u32 s61, s61, 0x180000
    s_lshl_b32 s72, s58, 17
    s_add_u32 s61, s61, s72
    s_add_u32 s61, s61, s83
    s_lshr_b32 s64, s52, 2
    s_mul_i32 s65, s64, 81920
    s_add_u32 s65, s65, s83
    s_lshl_b32 s72, s64, 16
    s_add_u32 s72, s72, s61
    s_mov_b32 s93, 0
    s_add_u32 s93, s58, s55
    s_lshl_b32 s75, s56, 1
    s_add_u32 s93, s93, s75
    s_and_b32 s93, s93, 7
    s_lshl_b32 s75, s64, 2
    s_xor_b32 s92, s93, s75
    s_xor_b32 s94, s92, 0
    s_lshl_b32 s94, s94, 13
    s_add_u32 s94, s94, s72
    s_xor_b32 s95, s92, 1
    s_lshl_b32 s95, s95, 13
    s_add_u32 s95, s95, s72
    s_xor_b32 s96, s92, 2
    s_lshl_b32 s96, s96, 13
    s_add_u32 s96, s96, s72
    s_xor_b32 s97, s92, 3
    s_lshl_b32 s97, s97, 13
    s_add_u32 s97, s97, s72
    s_xor_b32 s98, s92, 4
    s_lshl_b32 s98, s98, 13
    s_add_u32 s98, s98, s72
    s_xor_b32 s99, s92, 5
    s_lshl_b32 s99, s99, 13
    s_add_u32 s99, s99, s72
    s_xor_b32 s100, s92, 6
    s_lshl_b32 s100, s100, 13
    s_add_u32 s100, s100, s72
    s_xor_b32 s101, s92, 7
    s_lshl_b32 s101, s101, 13
    s_add_u32 s101, s101, s72
    s_lshl_b32 s3, s55, 2
    s_add_u32 s3, s3, s56
    s_lshl_b32 s3, s3, 1
    s_add_u32 s3, s3, s57
    s_lshl_b32 s3, s3, 2
    s_xor_b32 s91, s71, s64
    s_add_u32 s3, s3, s91
    s_lshl_b32 s3, s3, 2
    s_add_u32 s3, s3, s58
    s_cmp_ge_u32 s52, 4
    s_cbranch_scc1 L_loader
    s_lshl_b32 s72, s54, 1
    s_lshr_b32 s75, s52, 1
    s_add_u32 s72, s72, s75
    s_lshl_b32 s72, s72, 5
    s_lshr_b32 s75, s53, 1
    s_add_u32 s72, s72, s75
    s_and_b32 s75, s53, 1
    s_lshl_b32 s75, s75, 1
    s_and_b32 s76, s52, 1
    s_add_u32 s75, s75, s76
    s_lshl_b32 s73, s72, 13
    s_add_u32 s73, s73, 1048576
    s_lshl_b32 s76, s75, 11
    s_add_u32 s73, s73, s76
    s_lshl_b32 s72, s72, 7
    s_lshl_b32 s75, s75, 3
    s_add_u32 s72, s72, s75
    v_lshlrev_b32 v15, 4, v1
    v_mov_b32 v64, -1
    v_mov_b32 v65, -1
    v_mov_b32 v66, -1
    v_mov_b32 v67, -1
    v_lshrrev_b32 v29, 5, v1
    v_bfe_u32 v28, v1, 2, 2
    v_lshl_add_u32 v30, v29, 3, v28
    v_lshlrev_b32 v30, 7, v30
    v_bfe_u32 v28, v1, 3, 1
    s_and_b32 s75, s52, 1
    v_xor_b32 v28, s75, v28
    v_lshl_add_u32 v30, v28, 6, v30
    v_bfe_u32 v28, v1, 4, 1
    v_lshl_add_u32 v30, v28, 5, v30
    v_and_b32 v28, 3, v1
    v_lshl_add_u32 v32, v28, 3, v30
    v_add_u32 v33, 40960, v32
    v_add_u32 v34, 81920, v32
    v_add_u32 v35, 122880, v32
    v_and_b32 v28, 31, v1
    v_and_b32 v30, 15, v1
    v_xor_b32 v30, v30, v29
    v_lshlrev_b32 v30, 4, v30
    v_lshl_add_u32 v30, v28, 8, v30
    s_lshr_b32 s75, s52, 1
    s_lshl_b32 s75, s75, 13
    s_add_u32 s75, s75, 16384
    v_add_u32 v40, s75, v30
    v_xor_b32 v41, 32, v40
    v_xor_b32 v42, 64, v40
    v_xor_b32 v43, 96, v40
    v_xor_b32 v44, 128, v40
    v_xor_b32 v45, 160, v40
    v_xor_b32 v46, 192, v40
    v_xor_b32 v47, 224, v40
    v_add_u32 v48, 81920, v40
    v_add_u32 v49, 81920, v41
    v_add_u32 v50, 81920, v42
    v_add_u32 v51, 81920, v43
    v_add_u32 v52, 81920, v44
    v_add_u32 v53, 81920, v45
    v_add_u32 v54, 81920, v46
    v_add_u32 v55, 81920, v47
    s_barrier
    ds_read_b64_tr_b16 v[96:97], v32 offset:0
    ds_read_b64_tr_b16 v[98:99], v32 offset:512
    ds_read_b128 v[100:103], v40 offset:0
    ds_read_b64_tr_b16 v[104:105], v32 offset:2048
    ds_read_b64_tr_b16 v[106:107], v32 offset:2560
    ds_read_b128 v[108:111], v41 offset:0
    ds_read_b64_tr_b16 v[112:113], v32 offset:4096
    ds_read_b64_tr_b16 v[114:115], v32 offset:4608
    ds_read_b128 v[116:119], v42 offset:0
    ds_read_b64_tr_b16 v[120:121], v32 offset:6144
    ds_read_b64_tr_b16 v[122:123], v32 offset:6656
    ds_read_b128 v[124:127], v43 offset:0
    ds_read_b64_tr_b16 v[128:129], v32 offset:8192
    ds_read_b64_tr_b16 v[130:131], v32 offset:8704
    ds_read_b128 v[132:135], v44 offset:0
    ds_read_b64_tr_b16 v[136:137], v32 offset:10240
    ds_read_b64_tr_b16 v[138:139], v32 offset:10752
    ds_read_b128 v[140:143], v45 offset:0
    ds_read_b64_tr_b16 v[144:145], v32 offset:12288
    ds_read_b64_tr_b16 v[146:147], v32 offset:12800
    ds_read_b128 v[148:151], v46 offset:0
    ds_read_b64_tr_b16 v[152:153], v32 offset:14336
    ds_read_b64_tr_b16 v[154:155], v32 offset:14848
    ds_read_b128 v[156:159], v47 offset:0
    s_waitcnt lgkmcnt(0)
    s_barrier
    ds_read_b64_tr_b16 v[160:161], v33 offset:0
    ds_read_b64_tr_b16 v[162:163], v33 offset:512
    ds_read_b128 v[164:167], v40 offset:40960
    v_mfma_f32_32x32x16_bf16 v[64:79], v[96:99], v[100:103], 0
    ds_read_b64_tr_b16 v[168:169], v33 offset:2048
    ds_read_b64_tr_b16 v[170:171], v33 offset:2560
    ds_read_b128 v[172:175], v41 offset:40960
    v_mfma_f32_32x32x16_bf16 v[64:79], v[104:107], v[108:111], v[64:79]
    ds_read_b64_tr_b16 v[176:177], v33 offset:4096
    ds_read_b64_tr_b16 v[178:179], v33 offset:4608
    ds_read_b128 v[180:183], v42 offset:40960
    v_mfma_f32_32x32x16_bf16 v[64:79], v[112:115], v[116:119], v[64:79]
    ds_read_b64_tr_b16 v[184:185], v33 offset:6144
    ds_read_b64_tr_b16 v[186:187], v33 offset:6656
    ds_read_b128 v[188:191], v43 offset:40960
    v_mfma_f32_32x32x16_bf16 v[64:79], v[120:123], v[124:127], v[64:79]
    ds_read_b64_tr_b16 v[192:193], v33 offset:8192
    ds_read_b64_tr_b16 v[194:195], v33 offset:8704
    ds_read_b128 v[196:199], v44 offset:40960
    v_mfma_f32_32x32x16_bf16 v[64:79], v[128:131], v[132:135], v[64:79]
    ds_read_b64_tr_b16 v[200:201], v33 offset:10240
    ds_read_b64_tr_b16 v[202:203], v33 offset:10752
    ds_read_b128 v[204:207], v45 offset:40960
    v_mfma_f32_32x32x16_bf16 v[64:79], v[136:139], v[140:143], v[64:79]
    ds_read_b64_tr_b16 v[208:209], v33 offset:12288
    ds_read_b64_tr_b16 v[210:211], v33 offset:12800
    ds_read_b128 v[212:215], v46 offset:40960
    v_mfma_f32_32x32x16_bf16 v[64:79], v[144:147], v[148:151], v[64:79]
    ds_read_b64_tr_b16 v[216:217], v33 offset:14336
    ds_read_b64_tr_b16 v[218:219], v33 offset:14848
    ds_read_b128 v[220:223], v47 offset:40960
    v_mfma_f32_32x32x16_bf16 v[64:79], v[152:155], v[156:159], v[64:79]
    s_waitcnt lgkmcnt(0)
    s_barrier
    ds_read_b64_tr_b16 v[96:97], v34 offset:0
    ds_read_b64_tr_b16 v[98:99], v34 offset:512
    ds_read_b128 v[100:103], v48 offset:0
    v_mfma_f32_32x32x16_bf16 v[64:79], v[160:163], v[164:167], v[64:79]
    ds_read_b64_tr_b16 v[104:105], v34 offset:2048
    ds_read_b64_tr_b16 v[106:107], v34 offset:2560
    ds_read_b128 v[108:111], v49 offset:0
    v_mfma_f32_32x32x16_bf16 v[64:79], v[168:171], v[172:175], v[64:79]
    ds_read_b64_tr_b16 v[112:113], v34 offset:4096
    ds_read_b64_tr_b16 v[114:115], v34 offset:4608
    ds_read_b128 v[116:119], v50 offset:0
    v_mfma_f32_32x32x16_bf16 v[64:79], v[176:179], v[180:183], v[64:79]
    ds_read_b64_tr_b16 v[120:121], v34 offset:6144
    ds_read_b64_tr_b16 v[122:123], v34 offset:6656
    ds_read_b128 v[124:127], v51 offset:0
    v_mfma_f32_32x32x16_bf16 v[64:79], v[184:187], v[188:191], v[64:79]
    ds_read_b64_tr_b16 v[128:129], v34 offset:8192
    ds_read_b64_tr_b16 v[130:131], v34 offset:8704
    ds_read_b128 v[132:135], v52 offset:0
    v_mfma_f32_32x32x16_bf16 v[64:79], v[192:195], v[196:199], v[64:79]
    ds_read_b64_tr_b16 v[136:137], v34 offset:10240
    ds_read_b64_tr_b16 v[138:139], v34 offset:10752
    ds_read_b128 v[140:143], v53 offset:0
    v_mfma_f32_32x32x16_bf16 v[64:79], v[200:203], v[204:207], v[64:79]
    ds_read_b64_tr_b16 v[144:145], v34 offset:12288
    ds_read_b64_tr_b16 v[146:147], v34 offset:12800
    ds_read_b128 v[148:151], v54 offset:0
    v_mfma_f32_32x32x16_bf16 v[64:79], v[208:211], v[212:215], v[64:79]
    ds_read_b64_tr_b16 v[152:153], v34 offset:14336
    ds_read_b64_tr_b16 v[154:155], v34 offset:14848
    ds_read_b128 v[156:159], v55 offset:0
    v_mfma_f32_32x32x16_bf16 v[64:79], v[216:219], v[220:223], v[64:79]
    s_waitcnt lgkmcnt(0)
    s_barrier
    ds_read_b64_tr_b16 v[160:161], v35 offset:0
    ds_read_b64_tr_b16 v[162:163], v35 offset:512
    ds_read_b128 v[164:167], v48 offset:40960
    v_mfma_f32_32x32x16_bf16 v[64:79], v[96:99], v[100:103], v[64:79]
    ds_read_b64_tr_b16 v[168:169], v35 offset:2048
    ds_read_b64_tr_b16 v[170:171], v35 offset:2560
    ds_read_b128 v[172:175], v49 offset:40960
    v_mfma_f32_32x32x16_bf16 v[64:79], v[104:107], v[108:111], v[64:79]
    ds_read_b64_tr_b16 v[176:177], v35 offset:4096
    ds_read_b64_tr_b16 v[178:179], v35 offset:4608
    ds_read_b128 v[180:183], v50 offset:40960
    v_mfma_f32_32x32x16_bf16 v[64:79], v[112:115], v[116:119], v[64:79]
    ds_read_b64_tr_b16 v[184:185], v35 offset:6144
    ds_read_b64_tr_b16 v[186:187], v35 offset:6656
    ds_read_b128 v[188:191], v51 offset:40960
    v_mfma_f32_32x32x16_bf16 v[64:79], v[120:123], v[124:127], v[64:79]
    ds_read_b64_tr_b16 v[192:193], v35 offset:8192
    ds_read_b64_tr_b16 v[194:195], v35 offset:8704
    ds_read_b128 v[196:199], v52 offset:40960
    v_mfma_f32_32x32x16_bf16 v[64:79], v[128:131], v[132:135], v[64:79]
    ds_read_b64_tr_b16 v[200:201], v35 offset:10240
    ds_read_b64_tr_b16 v[202:203], v35 offset:10752
    ds_read_b128 v[204:207], v53 offset:40960
    v_mfma_f32_32x32x16_bf16 v[64:79], v[136:139], v[140:143], v[64:79]
    ds_read_b64_tr_b16 v[208:209], v35 offset:12288
    ds_read_b64_tr_b16 v[210:211], v35 offset:12800
    ds_read_b128 v[212:215], v54 offset:40960
    v_mfma_f32_32x32x16_bf16 v[64:79], v[144:147], v[148:151], v[64:79]
    ds_read_b64_tr_b16 v[216:217], v35 offset:14336
    ds_read_b64_tr_b16 v[218:219], v35 offset:14848
    ds_read_b128 v[220:223], v55 offset:40960
    v_mfma_f32_32x32x16_bf16 v[64:79], v[152:155], v[156:159], v[64:79]
    s_waitcnt lgkmcnt(0)
    v_mov_b32 v36, -1
    v_mov_b32 v37, -1
    v_mov_b32 v38, -1
    v_mov_b32 v39, -1
    buffer_store_dwordx4 v[36:39], v15, s[48:51], s73 offen sc1
    buffer_store_dwordx4 v[36:39], v15, s[48:51], s73 offen offset:1024 sc1
    s_barrier
    ds_read_b64_tr_b16 v[96:97], v32 offset:0
    ds_read_b64_tr_b16 v[98:99], v32 offset:512
    ds_read_b128 v[100:103], v40 offset:0
    v_mfma_f32_32x32x16_bf16 v[64:79], v[160:163], v[164:167], v[64:79]
    ds_read_b64_tr_b16 v[104:105], v32 offset:2048
    ds_read_b64_tr_b16 v[106:107], v32 offset:2560
    ds_read_b128 v[108:111], v41 offset:0
    v_mfma_f32_32x32x16_bf16 v[64:79], v[168:171], v[172:175], v[64:79]
    ds_read_b64_tr_b16 v[112:113], v32 offset:4096
    ds_read_b64_tr_b16 v[114:115], v32 offset:4608
    ds_read_b128 v[116:119], v42 offset:0
    v_mfma_f32_32x32x16_bf16 v[64:79], v[176:179], v[180:183], v[64:79]
    ds_read_b64_tr_b16 v[120:121], v32 offset:6144
    ds_read_b64_tr_b16 v[122:123], v32 offset:6656
    ds_read_b128 v[124:127], v43 offset:0
    v_mfma_f32_32x32x16_bf16 v[64:79], v[184:187], v[188:191], v[64:79]
    ds_read_b64_tr_b16 v[128:129], v32 offset:8192
    ds_read_b64_tr_b16 v[130:131], v32 offset:8704
    ds_read_b128 v[132:135], v44 offset:0
    v_mfma_f32_32x32x16_bf16 v[64:79], v[192:195], v[196:199], v[64:79]
    ds_read_b64_tr_b16 v[136:137], v32 offset:10240
    ds_read_b64_tr_b16 v[138:139], v32 offset:10752
    ds_read_b128 v[140:143], v45 offset:0
    v_mfma_f32_32x32x16_bf16 v[64:79], v[200:203], v[204:207], v[64:79]
    ds_read_b64_tr_b16 v[144:145], v32 offset:12288
    ds_read_b64_tr_b16 v[146:147], v32 offset:12800
    ds_read_b128 v[148:151], v46 offset:0
    v_mfma_f32_32x32x16_bf16 v[64:79], v[208:211], v[212:215], v[64:79]
    ds_read_b64_tr_b16 v[152:153], v32 offset:14336
    ds_read_b64_tr_b16 v[154:155], v32 offset:14848
    ds_read_b128 v[156:159], v47 offset:0
    v_mfma_f32_32x32x16_bf16 v[64:79], v[216:219], v[220:223], v[64:79]
    s_waitcnt lgkmcnt(0)
    v_mov_b32 v59, 0
    buffer_load_dwordx2 v[58:59], v59, s[44:47], 0 offen sc1
    s_barrier
    ds_read_b64_tr_b16 v[160:161], v33 offset:0
    ds_read_b64_tr_b16 v[162:163], v33 offset:512
    ds_read_b128 v[164:167], v40 offset:40960
    v_mfma_f32_32x32x16_bf16 v[64:79], v[96:99], v[100:103], v[64:79]
    ds_read_b64_tr_b16 v[168:169], v33 offset:2048
    ds_read_b64_tr_b16 v[170:171], v33 offset:2560
    ds_read_b128 v[172:175], v41 offset:40960
    v_mfma_f32_32x32x16_bf16 v[64:79], v[104:107], v[108:111], v[64:79]
    ds_read_b64_tr_b16 v[176:177], v33 offset:4096
    ds_read_b64_tr_b16 v[178:179], v33 offset:4608
    ds_read_b128 v[180:183], v42 offset:40960
    v_mfma_f32_32x32x16_bf16 v[64:79], v[112:115], v[116:119], v[64:79]
    ds_read_b64_tr_b16 v[184:185], v33 offset:6144
    ds_read_b64_tr_b16 v[186:187], v33 offset:6656
    ds_read_b128 v[188:191], v43 offset:40960
    v_mfma_f32_32x32x16_bf16 v[64:79], v[120:123], v[124:127], v[64:79]
    ds_read_b64_tr_b16 v[192:193], v33 offset:8192
    ds_read_b64_tr_b16 v[194:195], v33 offset:8704
    ds_read_b128 v[196:199], v44 offset:40960
    v_mfma_f32_32x32x16_bf16 v[64:79], v[128:131], v[132:135], v[64:79]
    ds_read_b64_tr_b16 v[200:201], v33 offset:10240
    ds_read_b64_tr_b16 v[202:203], v33 offset:10752
    ds_read_b128 v[204:207], v45 offset:40960
    v_mfma_f32_32x32x16_bf16 v[64:79], v[136:139], v[140:143], v[64:79]
    ds_read_b64_tr_b16 v[208:209], v33 offset:12288
    ds_read_b64_tr_b16 v[210:211], v33 offset:12800
    ds_read_b128 v[212:215], v46 offset:40960
    v_mfma_f32_32x32x16_bf16 v[64:79], v[144:147], v[148:151], v[64:79]
    ds_read_b64_tr_b16 v[216:217], v33 offset:14336
    ds_read_b64_tr_b16 v[218:219], v33 offset:14848
    ds_read_b128 v[220:223], v47 offset:40960
    v_mfma_f32_32x32x16_bf16 v[64:79], v[152:155], v[156:159], v[64:79]
    s_waitcnt lgkmcnt(0)
    s_barrier
    ds_read_b64_tr_b16 v[96:97], v34 offset:0
    ds_read_b64_tr_b16 v[98:99], v34 offset:512
    ds_read_b128 v[100:103], v48 offset:0
    v_mfma_f32_32x32x16_bf16 v[64:79], v[160:163], v[164:167], v[64:79]
    ds_read_b64_tr_b16 v[104:105], v34 offset:2048
    ds_read_b64_tr_b16 v[106:107], v34 offset:2560
    ds_read_b128 v[108:111], v49 offset:0
    v_mfma_f32_32x32x16_bf16 v[64:79], v[168:171], v[172:175], v[64:79]
    ds_read_b64_tr_b16 v[112:113], v34 offset:4096
    ds_read_b64_tr_b16 v[114:115], v34 offset:4608
    ds_read_b128 v[116:119], v50 offset:0
    v_mfma_f32_32x32x16_bf16 v[64:79], v[176:179], v[180:183], v[64:79]
    ds_read_b64_tr_b16 v[120:121], v34 offset:6144
    ds_read_b64_tr_b16 v[122:123], v34 offset:6656
    ds_read_b128 v[124:127], v51 offset:0
    v_mfma_f32_32x32x16_bf16 v[64:79], v[184:187], v[188:191], v[64:79]
    ds_read_b64_tr_b16 v[128:129], v34 offset:8192
    ds_read_b64_tr_b16 v[130:131], v34 offset:8704
    ds_read_b128 v[132:135], v52 offset:0
    v_mfma_f32_32x32x16_bf16 v[64:79], v[192:195], v[196:199], v[64:79]
    ds_read_b64_tr_b16 v[136:137], v34 offset:10240
    ds_read_b64_tr_b16 v[138:139], v34 offset:10752
    ds_read_b128 v[140:143], v53 offset:0
    v_mfma_f32_32x32x16_bf16 v[64:79], v[200:203], v[204:207], v[64:79]
    ds_read_b64_tr_b16 v[144:145], v34 offset:12288
    ds_read_b64_tr_b16 v[146:147], v34 offset:12800
    ds_read_b128 v[148:151], v54 offset:0
    v_mfma_f32_32x32x16_bf16 v[64:79], v[208:211], v[212:215], v[64:79]
    ds_read_b64_tr_b16 v[152:153], v34 offset:14336
    ds_read_b64_tr_b16 v[154:155], v34 offset:14848
    ds_read_b128 v[156:159], v55 offset:0
    v_mfma_f32_32x32x16_bf16 v[64:79], v[216:219], v[220:223], v[64:79]
    s_waitcnt lgkmcnt(0)
    s_waitcnt vmcnt(0)
    v_readfirstlane_b32 s62, v58
    v_readfirstlane_b32 s63, v59
    s_nop 0
    s_cmp_lg_u32 s62, 0
    s_cbranch_scc1 L_tagd_2
    s_mov_b32 s77, 0
L_tag_1:
    s_load_dwordx2 s[62:63], s[16:17], 0 glc
    s_waitcnt lgkmcnt(0)
    s_cmp_lg_u32 s62, 0
    s_cbranch_scc1 L_tagd_2
    s_add_u32 s77, s77, 1
    s_cmp_lt_u32 s77, 40000
    s_cbranch_scc1 L_tag_1
L_tagd_2:
    s_waitcnt vmcnt(0)
    s_barrier
    ds_read_b64_tr_b16 v[160:161], v35 offset:0
    ds_read_b64_tr_b16 v[162:163], v35 offset:512
    ds_read_b128 v[164:167], v48 offset:40960
    ds_read_b64_tr_b16 v[168:169], v35 offset:2048
    ds_read_b64_tr_b16 v[170:171], v35 offset:2560
    ds_read_b128 v[172:175], v49 offset:40960
    ds_read_b64_tr_b16 v[176:177], v35 offset:4096
    ds_read_b64_tr_b16 v[178:179], v35 offset:4608
    ds_read_b128 v[180:183], v50 offset:40960
    ds_read_b64_tr_b16 v[184:185], v35 offset:6144
    ds_read_b64_tr_b16 v[186:187], v35 offset:6656
    ds_read_b128 v[188:191], v51 offset:40960
    v_mfma_f32_32x32x16_bf16 v[64:79], v[96:99], v[100:103], v[64:79]
    ds_read_b64_tr_b16 v[192:193], v35 offset:8192
    ds_read_b64_tr_b16 v[194:195], v35 offset:8704
    ds_read_b128 v[196:199], v52 offset:40960
    v_mfma_f32_32x32x16_bf16 v[64:79], v[104:107], v[108:111], v[64:79]
    ds_read_b64_tr_b16 v[200:201], v35 offset:10240
    ds_read_b64_tr_b16 v[202:203], v35 offset:10752
    ds_read_b128 v[204:207], v53 offset:40960
    v_mfma_f32_32x32x16_bf16 v[64:79], v[112:115], v[116:119], v[64:79]
    ds_read_b64_tr_b16 v[208:209], v35 offset:12288
    ds_read_b64_tr_b16 v[210:211], v35 offset:12800
    ds_read_b128 v[212:215], v54 offset:40960
    v_mfma_f32_32x32x16_bf16 v[64:79], v[120:123], v[124:127], v[64:79]
    ds_read_b64_tr_b16 v[216:217], v35 offset:14336
    ds_read_b64_tr_b16 v[218:219], v35 offset:14848
    ds_read_b128 v[220:223], v55 offset:40960
    v_mfma_f32_32x32x16_bf16 v[64:79], v[128:131], v[132:135], v[64:79]
    v_mfma_f32_32x32x16_bf16 v[64:79], v[136:139], v[140:143], v[64:79]
    v_mfma_f32_32x32x16_bf16 v[64:79], v[144:147], v[148:151], v[64:79]
    v_mfma_f32_32x32x16_bf16 v[64:79], v[152:155], v[156:159], v[64:79]
    s_waitcnt lgkmcnt(0)
    v_mfma_f32_32x32x16_bf16 v[64:79], v[160:163], v[164:167], v[64:79]
    v_mfma_f32_32x32x16_bf16 v[64:79], v[168:171], v[172:175], v[64:79]
    v_mfma_f32_32x32x16_bf16 v[64:79], v[176:179], v[180:183], v[64:79]
    v_mfma_f32_32x32x16_bf16 v[64:79], v[184:187], v[188:191], v[64:79]
    v_mfma_f32_32x32x16_bf16 v[64:79], v[192:195], v[196:199], v[64:79]
    v_mfma_f32_32x32x16_bf16 v[64:79], v[200:203], v[204:207], v[64:79]
    v_mfma_f32_32x32x16_bf16 v[64:79], v[208:211], v[212:215], v[64:79]
    v_mfma_f32_32x32x16_bf16 v[64:79], v[216:219], v[220:223], v[64:79]
    s_nop 11
    v_mul_f32 v64, s66, v64
    v_mul_f32 v65, s66, v65
    v_mul_f32 v66, s66, v66
    v_mul_f32 v67, s66, v67
    v_mul_f32 v68, s66, v68
    v_mul_f32 v69, s66, v69
    v_mul_f32 v70, s66, v70
    v_mul_f32 v71, s66, v71
    v_mul_f32 v72, s66, v72
    v_mul_f32 v73, s66, v73
    v_mul_f32 v74, s66, v74
    v_mul_f32 v75, s66, v75
    v_mul_f32 v76, s66, v76
    v_mul_f32 v77, s66, v77
    v_mul_f32 v78, s66, v78
    v_mul_f32 v79, s66, v79
    v_cvt_pk_bf16_f32 v80, v64, v65
    v_cvt_pk_bf16_f32 v81, v66, v67
    v_cvt_pk_bf16_f32 v82, v68, v69
    v_cvt_pk_bf16_f32 v83, v70, v71
    v_cvt_pk_bf16_f32 v84, v72, v73
    v_cvt_pk_bf16_f32 v85, v74, v75
    v_cvt_pk_bf16_f32 v86, v76, v77
    v_cvt_pk_bf16_f32 v87, v78, v79
    v_min_u32 v80, -2, v80
    v_min_u32 v81, -2, v81
    v_min_u32 v82, -2, v82
    v_min_u32 v83, -2, v83
    v_min_u32 v84, -2, v84
    v_min_u32 v85, -2, v85
    v_min_u32 v86, -2, v86
    v_min_u32 v87, -2, v87
    v_permlane32_swap_b32 v80, v82
    v_permlane32_swap_b32 v81, v83
    v_permlane32_swap_b32 v84, v86
    v_permlane32_swap_b32 v85, v87
    buffer_store_dwordx4 v[80:83], v15, s[48:51], s73 offen sc1
    buffer_store_dwordx4 v[84:87], v15, s[48:51], s73 offen offset:1024 sc1
    v_mov_b32 v28, s62
    v_mov_b32 v29, s63
    v_mov_b32 v30, 0
    s_mov_b64 exec, 1
    buffer_store_dwordx2 v[28:29], v30, s[48:51], s72 offen sc1
    s_mov_b64 exec, -1
    s_barrier
    s_xor_b32 s75, s93, 4
    s_lshl_b32 s75, s75, 13
    s_add_u32 s75, s75, s61
    s_add_u32 s75, s75, 0x10000
    s_add_u32 m0, s83, 98304
    s_nop 0
    buffer_load_dwordx4 v6, s[28:31], s75 offen offset:0 nt lds
    buffer_load_dwordx4 v6, s[28:31], s75 offen offset:1024 nt lds
    s_xor_b32 s75, s93, 2
    s_lshl_b32 s75, s75, 13
    s_add_u32 s75, s75, s61
    s_add_u32 m0, s83, 24576
    s_nop 0
    buffer_load_dwordx4 v2, s[24:27], s75 offen offset:0 nt lds
    buffer_load_dwordx4 v3, s[24:27], s75 offen offset:1024 nt lds
    s_xor_b32 s75, s93, 6
    s_lshl_b32 s75, s75, 13
    s_add_u32 s75, s75, s61
    s_add_u32 s75, s75, 0x10000
    s_add_u32 m0, s83, 106496
    s_nop 0
    buffer_load_dwordx4 v2, s[24:27], s75 offen offset:0 nt lds
    buffer_load_dwordx4 v3, s[24:27], s75 offen offset:1024 nt lds
    s_branch L_qdone
L_loader:
    s_add_u32 s76, s78, 2
    s_and_b32 s76, s76, 7
    s_lshl_b32 s77, s76, 8
    s_add_u32 s77, s77, s81
    s_add_u32 m0, s79, 81920
    s_lshl_b32 s76, s76, 20
    s_add_u32 s76, s76, s80
    buffer_load_dwordx4 v16, s[32:35], s76 offen offset:0 lds
    buffer_load_dwordx4 v17, s[32:35], s76 offen offset:1024 lds
    buffer_load_dwordx4 v18, s[32:35], s76 offen offset:2048 lds
    buffer_load_dwordx4 v19, s[32:35], s76 offen offset:3072 lds
    s_add_u32 m0, s79, 98304
    s_nop 0
    buffer_load_dwordx4 v20, s[20:23], s77 offen offset:0 lds
    buffer_load_dwordx4 v21, s[20:23], s77 offen offset:1024 lds
    buffer_load_dwordx4 v22, s[20:23], s77 offen offset:2048 lds
    buffer_load_dwordx4 v23, s[20:23], s77 offen offset:3072 lds
    s_waitcnt vmcnt(16)
    s_barrier
    s_add_u32 s76, s78, 3
    s_and_b32 s76, s76, 7
    s_lshl_b32 s77, s76, 8
    s_add_u32 s77, s77, s81
    s_add_u32 m0, s79, 122880
    s_lshl_b32 s76, s76, 20
    s_add_u32 s76, s76, s80
    buffer_load_dwordx4 v16, s[32:35], s76 offen offset:0 lds
    buffer_load_dwordx4 v17, s[32:35], s76 offen offset:1024 lds
    buffer_load_dwordx4 v18, s[32:35], s76 offen offset:2048 lds
    buffer_load_dwordx4 v19, s[32:35], s76 offen offset:3072 lds
    s_add_u32 m0, s79, 139264
    s_nop 0
    buffer_load_dwordx4 v20, s[20:23], s77 offen offset:0 lds
    buffer_load_dwordx4 v21, s[20:23], s77 offen offset:1024 lds
    buffer_load_dwordx4 v22, s[20:23], s77 offen offset:2048 lds
    buffer_load_dwordx4 v23, s[20:23], s77 offen offset:3072 lds
    s_waitcnt vmcnt(16)
    s_barrier
    s_add_u32 s76, s78, 4
    s_and_b32 s76, s76, 7
    s_lshl_b32 s77, s76, 8
    s_add_u32 s77, s77, s81
    s_add_u32 m0, s79, 0
    s_lshl_b32 s76, s76, 20
    s_add_u32 s76, s76, s80
    buffer_load_dwordx4 v16, s[32:35], s76 offen offset:0 lds
    buffer_load_dwordx4 v17, s[32:35], s76 offen offset:1024 lds
    buffer_load_dwordx4 v18, s[32:35], s76 offen offset:2048 lds
    buffer_load_dwordx4 v19, s[32:35], s76 offen offset:3072 lds
    s_add_u32 m0, s79, 16384
    s_nop 0
    buffer_load_dwordx4 v20, s[20:23], s77 offen offset:0 lds
    buffer_load_dwordx4 v21, s[20:23], s77 offen offset:1024 lds
    buffer_load_dwordx4 v22, s[20:23], s77 offen offset:2048 lds
    buffer_load_dwordx4 v23, s[20:23], s77 offen offset:3072 lds
    s_waitcnt vmcnt(16)
    s_barrier
    s_add_u32 s76, s78, 5
    s_and_b32 s76, s76, 7
    s_lshl_b32 s77, s76, 8
    s_add_u32 s77, s77, s81
    s_add_u32 m0, s79, 40960
    s_lshl_b32 s76, s76, 20
    s_add_u32 s76, s76, s80
    buffer_load_dwordx4 v16, s[32:35], s76 offen offset:0 lds
    buffer_load_dwordx4 v17, s[32:35], s76 offen offset:1024 lds
    buffer_load_dwordx4 v18, s[32:35], s76 offen offset:2048 lds
    buffer_load_dwordx4 v19, s[32:35], s76 offen offset:3072 lds
    s_add_u32 m0, s79, 57344
    s_nop 0
    buffer_load_dwordx4 v20, s[20:23], s77 offen offset:0 lds
    buffer_load_dwordx4 v21, s[20:23], s77 offen offset:1024 lds
    buffer_load_dwordx4 v22, s[20:23], s77 offen offset:2048 lds
    buffer_load_dwordx4 v23, s[20:23], s77 offen offset:3072 lds
    s_waitcnt vmcnt(16)
    s_barrier
    s_add_u32 s76, s78, 6
    s_and_b32 s76, s76, 7
    s_lshl_b32 s77, s76, 8
    s_add_u32 s77, s77, s81
    s_add_u32 m0, s79, 81920
    s_lshl_b32 s76, s76, 20
    s_add_u32 s76, s76, s80
    buffer_load_dwordx4 v16, s[32:35], s76 offen offset:0 lds
    buffer_load_dwordx4 v17, s[32:35], s76 offen offset:1024 lds
    buffer_load_dwordx4 v18, s[32:35], s76 offen offset:2048 lds
    buffer_load_dwordx4 v19, s[32:35], s76 offen offset:3072 lds
    s_add_u32 m0, s79, 98304
    s_nop 0
    buffer_load_dwordx4 v20, s[20:23], s77 offen offset:0 lds
    buffer_load_dwordx4 v21, s[20:23], s77 offen offset:1024 lds
    buffer_load_dwordx4 v22, s[20:23], s77 offen offset:2048 lds
    buffer_load_dwordx4 v23, s[20:23], s77 offen offset:3072 lds
    s_waitcnt vmcnt(16)
    s_barrier
    s_add_u32 s76, s78, 7
    s_and_b32 s76, s76, 7
    s_lshl_b32 s77, s76, 8
    s_add_u32 s77, s77, s81
    s_add_u32 m0, s79, 122880
    s_lshl_b32 s76, s76, 20
    s_add_u32 s76, s76, s80
    buffer_load_dwordx4 v16, s[32:35], s76 offen offset:0 lds
    buffer_load_dwordx4 v17, s[32:35], s76 offen offset:1024 lds
    buffer_load_dwordx4 v18, s[32:35], s76 offen offset:2048 lds
    buffer_load_dwordx4 v19, s[32:35], s76 offen offset:3072 lds
    s_add_u32 m0, s79, 139264
    s_nop 0
    buffer_load_dwordx4 v20, s[20:23], s77 offen offset:0 lds
    buffer_load_dwordx4 v21, s[20:23], s77 offen offset:1024 lds
    buffer_load_dwordx4 v22, s[20:23], s77 offen offset:2048 lds
    buffer_load_dwordx4 v23, s[20:23], s77 offen offset:3072 lds
    s_load_dwordx2 s[62:63], s[16:17], 0
    s_waitcnt vmcnt(16)
    s_barrier
    s_xor_b32 s75, s93, 0
    s_lshl_b32 s75, s75, 13
    s_add_u32 s75, s75, s61
    s_add_u32 m0, s83, 0
    s_nop 0
    buffer_load_dwordx4 v2, s[24:27], s75 offen offset:0 nt lds
    buffer_load_dwordx4 v3, s[24:27], s75 offen offset:1024 nt lds
    s_xor_b32 s75, s93, 1
    s_lshl_b32 s75, s75, 13
    s_add_u32 s75, s75, s61
    s_add_u32 m0, s83, 8192
    s_nop 0
    buffer_load_dwordx4 v2, s[24:27], s75 offen offset:0 nt lds
    buffer_load_dwordx4 v3, s[24:27], s75 offen offset:1024 nt lds
    s_waitcnt vmcnt(12)
    s_barrier
    s_xor_b32 s75, s93, 0
    s_lshl_b32 s75, s75, 13
    s_add_u32 s75, s75, s61
    s_add_u32 m0, s83, 16384
    s_nop 0
    buffer_load_dwordx4 v6, s[28:31], s75 offen offset:0 nt lds
    buffer_load_dwordx4 v6, s[28:31], s75 offen offset:1024 nt lds
    s_waitcnt vmcnt(6)
    s_barrier
    s_waitcnt lgkmcnt(0)
    s_cmp_lg_u32 s62, 0
    s_cbranch_scc1 L_tagd_4
    s_mov_b32 s77, 0
L_tag_3:
    s_load_dwordx2 s[62:63], s[16:17], 0 glc
    s_waitcnt lgkmcnt(0)
    s_cmp_lg_u32 s62, 0
    s_cbranch_scc1 L_tagd_4
    s_add_u32 s77, s77, 1
    s_cmp_lt_u32 s77, 40000
    s_cbranch_scc1 L_tag_3
L_tagd_4:
    s_xor_b32 s75, s93, 4
    s_lshl_b32 s75, s75, 13
    s_add_u32 s75, s75, s61
    s_add_u32 s75, s75, 0x10000
    s_add_u32 m0, s83, 81920
    s_nop 0
    buffer_load_dwordx4 v2, s[24:27], s75 offen offset:0 nt lds
    buffer_load_dwordx4 v3, s[24:27], s75 offen offset:1024 nt lds
    s_xor_b32 s75, s93, 5
    s_lshl_b32 s75, s75, 13
    s_add_u32 s75, s75, s61
    s_add_u32 s75, s75, 0x10000
    s_add_u32 m0, s83, 90112
    s_nop 0
    buffer_load_dwordx4 v2, s[24:27], s75 offen offset:0 nt lds
    buffer_load_dwordx4 v3, s[24:27], s75 offen offset:1024 nt lds
    s_lshr_b32 s72, s3, 2
    s_lshl_b32 s73, s72, 7
    s_add_u32 s73, s73, 0
    s_lshl_b32 s74, s72, 13
    s_add_u32 s74, s74, 1048576
    v_lshlrev_b32 v15, 4, v1
    s_lshr_b32 s72, s91, 1
    s_mul_i32 s72, s72, 81920
    s_and_b32 s75, s91, 1
    s_lshl_b32 s75, s75, 13
    s_add_u32 s72, s72, s75
    s_barrier
    s_mov_b32 s77, 0
L_poll_5:
    s_load_dwordx8 s[4:11], s[18:19], s73 glc
    s_waitcnt lgkmcnt(0)
    s_mov_b32 s76, 1
    s_cmp_eq_u64 s[4:5], s[62:63]
    s_cselect_b32 s76, s76, 0
    s_cmp_eq_u64 s[6:7], s[62:63]
    s_cselect_b32 s76, s76, 0
    s_cmp_eq_u64 s[8:9], s[62:63]
    s_cselect_b32 s76, s76, 0
    s_cmp_eq_u64 s[10:11], s[62:63]
    s_cselect_b32 s76, s76, 0
    s_cmp_lg_u32 s76, 0
    s_cbranch_scc1 L_polld_6
    s_add_u32 s77, s77, 1
    s_cmp_lt_u32 s77, 40000
    s_cbranch_scc1 L_poll_5
L_polld_6:
    s_add_u32 m0, s72, 65536
    s_nop 0
    buffer_load_dwordx4 v15, s[48:51], s74 offen offset:0 sc1 lds
    buffer_load_dwordx4 v15, s[48:51], s74 offen offset:1024 sc1 lds
    buffer_load_dwordx4 v15, s[48:51], s74 offen offset:2048 sc1 lds
    buffer_load_dwordx4 v15, s[48:51], s74 offen offset:3072 sc1 lds
    s_add_u32 s74, s74, 4096
    s_add_u32 m0, s72, 69632
    s_nop 0
    buffer_load_dwordx4 v15, s[48:51], s74 offen offset:0 sc1 lds
    buffer_load_dwordx4 v15, s[48:51], s74 offen offset:1024 sc1 lds
    buffer_load_dwordx4 v15, s[48:51], s74 offen offset:2048 sc1 lds
    buffer_load_dwordx4 v15, s[48:51], s74 offen offset:3072 sc1 lds
L_qdone:
    s_mul_i32 s73, s64, 81920
    s_lshl_b32 s72, s64, 1
    v_and_b32 v28, 31, v1
    v_lshrrev_b32 v29, 5, v1
    v_and_b32 v30, 15, v1
    v_xor_b32 v30, v30, v29
    v_lshlrev_b32 v30, 4, v30
    v_lshl_add_u32 v30, v28, 8, v30
    v_add_u32 v8, s73, v30
    v_xor_b32 v9, 32, v8
    v_xor_b32 v10, 64, v8
    v_xor_b32 v11, 96, v8
    v_xor_b32 v12, 128, v8
    v_xor_b32 v13, 160, v8
    v_xor_b32 v14, 192, v8
    v_xor_b32 v15, 224, v8
    v_bfe_u32 v28, v1, 2, 2
    v_lshl_add_u32 v30, v29, 2, v28
    v_lshlrev_b32 v30, 8, v30
    v_xor_b32 v28, s72, v28
    v_lshl_add_u32 v30, v28, 6, v30
    v_bfe_u32 v28, v1, 4, 1
    v_lshl_add_u32 v30, v28, 5, v30
    v_and_b32 v28, 3, v1
    v_lshl_add_u32 v30, v28, 3, v30
    v_add_u32 v20, s73, v30
    v_xor_b32 v21, 64, v20
    v_xor_b32 v22, 128, v20
    v_xor_b32 v23, 192, v20
    v_mov_b32 v26, 0
    v_mov_b32 v27, 0
    s_lshr_b32 s72, s91, 1
    s_mul_i32 s72, s72, 81920
    s_and_b32 s75, s91, 1
    s_lshl_b32 s75, s75, 13
    s_add_u32 s72, s72, s75
    s_add_u32 s72, s72, 65536
    v_lshlrev_b32 v17, 4, v1
    v_add_u32 v18, s72, v17
    s_lshr_b32 s74, s3, 2
    s_lshl_b32 s74, s74, 13
    s_add_u32 s74, s74, 1048576
    s_add_u32 s73, s74, 4096
    s_lshl_b32 s82, s56, 3
    s_add_u32 s82, s82, s52
    s_lshl_b32 s82, s82, 18
    s_lshl_b32 s75, s59, 8
    s_add_u32 s82, s82, s75
    s_add_u32 s84, s60, 0
    s_and_b32 s84, s84, 3
    s_add_u32 s85, s60, 1
    s_and_b32 s85, s85, 3
    s_add_u32 s86, s60, 2
    s_and_b32 s86, s86, 3
    s_add_u32 s87, s60, 3
    s_and_b32 s87, s87, 3
    s_lshl_b32 s83, s84, 16
    s_add_u32 s83, s83, s82
    s_lshr_b32 s75, s60, 2
    s_lshl_b32 s75, s75, 15
    s_add_u32 s83, s83, s75
    v_bfe_u32 v19, v1, 1, 4
    v_lshlrev_b32 v19, 11, v19
    v_and_b32 v28, 1, v1
    v_lshl_add_u32 v19, v28, 7, v19
    s_waitcnt vmcnt(0)
    s_barrier
    ds_read_b128 v[160:163], v18 offset:0
    ds_read_b128 v[164:167], v18 offset:1024
    ds_read_b128 v[168:171], v18 offset:2048
    ds_read_b128 v[172:175], v18 offset:3072
    ds_read_b128 v[176:179], v18 offset:4096
    ds_read_b128 v[180:183], v18 offset:5120
    ds_read_b128 v[184:187], v18 offset:6144
    ds_read_b128 v[188:191], v18 offset:7168
    ds_read_b128 v[128:131], v8 offset:0
    ds_read_b128 v[132:135], v9 offset:0
    ds_read_b128 v[136:139], v10 offset:0
    ds_read_b128 v[140:143], v11 offset:0
    ds_read_b128 v[144:147], v12 offset:0
    ds_read_b128 v[148:151], v13 offset:0
    ds_read_b128 v[152:155], v14 offset:0
    s_add_u32 m0, s65, 32768
    s_nop 0
    buffer_load_dwordx4 v6, s[28:31], s95 offen offset:0 nt lds
    buffer_load_dwordx4 v6, s[28:31], s95 offen offset:1024 nt lds
    s_waitcnt lgkmcnt(7)
    ds_read_b128 v[156:159], v15 offset:0
    v_max3_u32 v28, v160, v161, v162
    v_max3_u32 v28, v28, v163, v164
    v_max3_u32 v28, v28, v165, v166
    v_max3_u32 v28, v28, v167, v168
    v_max3_u32 v28, v28, v169, v170
    v_max3_u32 v28, v28, v171, v172
    v_max3_u32 v28, v28, v173, v174
    v_max3_u32 v28, v28, v175, v176
    v_max3_u32 v28, v28, v177, v178
    v_max3_u32 v28, v28, v179, v180
    v_max3_u32 v28, v28, v181, v182
    v_max3_u32 v28, v28, v183, v184
    v_max3_u32 v28, v28, v185, v186
    v_max3_u32 v28, v28, v187, v188
    v_max3_u32 v28, v28, v189, v190
    v_max_u32 v28, v28, v191
    v_cmp_eq_u32 vcc, -1, v28
    s_nop 1
    s_cbranch_vccnz L_retry_7
L_valid_8:
    s_waitcnt lgkmcnt(7)
    v_mfma_f32_32x32x16_bf16 v[64:79], v[128:131], v[160:163], 0
    ds_read_b128 v[96:99], v8 offset:8192
    s_waitcnt lgkmcnt(7)
    v_mfma_f32_32x32x16_bf16 v[64:79], v[132:135], v[164:167], v[64:79]
    ds_read_b128 v[100:103], v9 offset:8192
    s_add_u32 m0, s65, 40960
    s_nop 0
    buffer_load_dwordx4 v2, s[24:27], s97 offen offset:0 nt lds
    s_waitcnt lgkmcnt(7)
    v_mfma_f32_32x32x16_bf16 v[64:79], v[136:139], v[168:171], v[64:79]
    ds_read_b128 v[104:107], v10 offset:8192
    s_waitcnt lgkmcnt(7)
    v_mfma_f32_32x32x16_bf16 v[64:79], v[140:143], v[172:175], v[64:79]
    ds_read_b128 v[108:111], v11 offset:8192
    buffer_load_dwordx4 v3, s[24:27], s97 offen offset:1024 nt lds
    s_waitcnt lgkmcnt(7)
    v_mfma_f32_32x32x16_bf16 v[64:79], v[144:147], v[176:179], v[64:79]
    ds_read_b128 v[112:115], v12 offset:8192
    s_waitcnt lgkmcnt(7)
    v_mfma_f32_32x32x16_bf16 v[64:79], v[148:151], v[180:183], v[64:79]
    ds_read_b128 v[116:119], v13 offset:8192
    s_waitcnt lgkmcnt(7)
    v_mfma_f32_32x32x16_bf16 v[64:79], v[152:155], v[184:187], v[64:79]
    ds_read_b128 v[120:123], v14 offset:8192
    s_waitcnt lgkmcnt(7)
    v_mfma_f32_32x32x16_bf16 v[64:79], v[156:159], v[188:191], v[64:79]
    ds_read_b128 v[124:127], v15 offset:8192
    s_nop 10
    v_max3_f32 v28, v64, v65, v66
    v_max3_f32 v28, v28, v67, v68
    v_max3_f32 v28, v28, v69, v70
    v_max3_f32 v28, v28, v71, v72
    v_max3_f32 v28, v28, v73, v74
    v_max3_f32 v28, v28, v75, v76
    v_max3_f32 v28, v28, v77, v78
    v_max_f32 v28, v28, v79
    v_mov_b32 v29, v28
    s_nop 1
    v_permlane32_swap_b32 v29, v28
    v_max_f32 v24, v28, v29
    v_sub_f32 v64, v64, v24
    v_sub_f32 v65, v65, v24
    v_sub_f32 v66, v66, v24
    v_sub_f32 v67, v67, v24
    v_sub_f32 v68, v68, v24
    v_sub_f32 v69, v69, v24
    v_sub_f32 v70, v70, v24
    v_sub_f32 v71, v71, v24
    v_sub_f32 v72, v72, v24
    v_sub_f32 v73, v73, v24
    v_sub_f32 v74, v74, v24
    v_sub_f32 v75, v75, v24
    v_sub_f32 v76, v76, v24
    v_sub_f32 v77, v77, v24
    v_sub_f32 v78, v78, v24
    v_sub_f32 v79, v79, v24
    v_sub_f32 v32, 0, v24
    v_sub_f32 v33, 0, v24
    v_sub_f32 v34, 0, v24
    v_sub_f32 v35, 0, v24
    v_sub_f32 v36, 0, v24
    v_sub_f32 v37, 0, v24
    v_sub_f32 v38, 0, v24
    v_sub_f32 v39, 0, v24
    v_sub_f32 v40, 0, v24
    v_sub_f32 v41, 0, v24
    v_sub_f32 v42, 0, v24
    v_sub_f32 v43, 0, v24
    v_sub_f32 v44, 0, v24
    v_sub_f32 v45, 0, v24
    v_sub_f32 v46, 0, v24
    v_sub_f32 v47, 0, v24
    v_exp_f32 v64, v64
    v_exp_f32 v65, v65
    v_exp_f32 v66, v66
    v_exp_f32 v67, v67
    v_exp_f32 v68, v68
    v_exp_f32 v69, v69
    v_exp_f32 v70, v70
    v_exp_f32 v71, v71
    s_waitcnt lgkmcnt(0) vmcnt(4)
    s_barrier
    v_mfma_f32_32x32x16_bf16 v[80:95], v[96:99], v[160:163], v[32:47]
    s_add_u32 m0, s65, 57344
    s_nop 0
    buffer_load_dwordx4 v2, s[24:27], s98 offen offset:0 nt lds
    ds_read_b64_tr_b16 v[136:137], v22 offset:16384
    ds_read_b64_tr_b16 v[138:139], v22 offset:18432
    ds_read_b64_tr_b16 v[140:141], v23 offset:16384
    v_mfma_f32_32x32x16_bf16 v[80:95], v[100:103], v[164:167], v[80:95]
    ds_read_b64_tr_b16 v[142:143], v23 offset:18432
    ds_read_b64_tr_b16 v[128:129], v20 offset:16384
    ds_read_b64_tr_b16 v[130:131], v20 offset:18432
    v_mfma_f32_32x32x16_bf16 v[80:95], v[104:107], v[168:171], v[80:95]
    ds_read_b64_tr_b16 v[132:133], v21 offset:16384
    ds_read_b64_tr_b16 v[134:135], v21 offset:18432
    v_mfma_f32_32x32x16_bf16 v[80:95], v[108:111], v[172:175], v[80:95]
    ds_read_b64_tr_b16 v[152:153], v22 offset:20480
    ds_read_b64_tr_b16 v[154:155], v22 offset:22528
    ds_read_b64_tr_b16 v[156:157], v23 offset:20480
    v_mfma_f32_32x32x16_bf16 v[80:95], v[112:115], v[176:179], v[80:95]
    buffer_load_dwordx4 v3, s[24:27], s98 offen offset:1024 nt lds
    ds_read_b64_tr_b16 v[158:159], v23 offset:22528
    ds_read_b64_tr_b16 v[144:145], v20 offset:20480
    ds_read_b64_tr_b16 v[146:147], v20 offset:22528
    v_mfma_f32_32x32x16_bf16 v[80:95], v[116:119], v[180:183], v[80:95]
    ds_read_b64_tr_b16 v[148:149], v21 offset:20480
    ds_read_b64_tr_b16 v[150:151], v21 offset:22528
    v_mfma_f32_32x32x16_bf16 v[80:95], v[120:123], v[184:187], v[80:95]
    v_mfma_f32_32x32x16_bf16 v[80:95], v[124:127], v[188:191], v[80:95]
    v_exp_f32 v72, v72
    v_exp_f32 v73, v73
    v_exp_f32 v74, v74
    v_exp_f32 v75, v75
    v_exp_f32 v76, v76
    v_exp_f32 v77, v77
    v_exp_f32 v78, v78
    v_exp_f32 v79, v79
    v_pk_add_f32 v[26:27], v[26:27], v[64:65]
    v_cvt_pk_bf16_f32 v56, v64, v65
    v_pk_add_f32 v[26:27], v[26:27], v[66:67]
    v_cvt_pk_bf16_f32 v57, v66, v67
    v_pk_add_f32 v[26:27], v[26:27], v[68:69]
    v_cvt_pk_bf16_f32 v58, v68, v69
    v_pk_add_f32 v[26:27], v[26:27], v[70:71]
    v_cvt_pk_bf16_f32 v59, v70, v71
    v_pk_add_f32 v[26:27], v[26:27], v[72:73]
    v_cvt_pk_bf16_f32 v60, v72, v73
    v_pk_add_f32 v[26:27], v[26:27], v[74:75]
    v_cvt_pk_bf16_f32 v61, v74, v75
    s_waitcnt lgkmcnt(0)
    v_mfma_f32_32x32x16_bf16 v[224:239], v[136:139], v[56:59], 0
    s_add_u32 m0, s65, 49152
    s_nop 0
    buffer_load_dwordx4 v6, s[28:31], s96 offen offset:0 nt lds
    v_pk_add_f32 v[26:27], v[26:27], v[76:77]
    v_cvt_pk_bf16_f32 v62, v76, v77
    ds_read_b128 v[96:99], v8 offset:24576
    ds_read_b128 v[100:103], v9 offset:24576
    v_mfma_f32_32x32x16_bf16 v[240:255], v[140:143], v[56:59], 0
    v_pk_add_f32 v[26:27], v[26:27], v[78:79]
    v_cvt_pk_bf16_f32 v63, v78, v79
    ds_read_b128 v[104:107], v10 offset:24576
    v_mfma_f32_32x32x16_bf16 v[192:207], v[128:131], v[56:59], 0
    ds_read_b128 v[108:111], v11 offset:24576
    v_mfma_f32_32x32x16_bf16 v[208:223], v[132:135], v[56:59], 0
    ds_read_b128 v[112:115], v12 offset:24576
    ds_read_b128 v[116:119], v13 offset:24576
    v_mfma_f32_32x32x16_bf16 v[224:239], v[152:155], v[60:63], v[224:239]
    buffer_load_dwordx4 v6, s[28:31], s96 offen offset:1024 nt lds
    ds_read_b128 v[120:123], v14 offset:24576
    v_mfma_f32_32x32x16_bf16 v[240:255], v[156:159], v[60:63], v[240:255]
    ds_read_b128 v[124:127], v15 offset:24576
    v_mfma_f32_32x32x16_bf16 v[192:207], v[144:147], v[60:63], v[192:207]
    v_mfma_f32_32x32x16_bf16 v[208:223], v[148:151], v[60:63], v[208:223]
    v_max3_f32 v28, v80, v81, v82
    v_max3_f32 v28, v28, v83, v84
    v_max3_f32 v28, v28, v85, v86
    v_max3_f32 v28, v28, v87, v88
    v_max3_f32 v28, v28, v89, v90
    v_max3_f32 v28, v28, v91, v92
    v_max3_f32 v28, v28, v93, v94
    v_max_f32 v28, v28, v95
    v_cmp_lt_f32 vcc, s67, v28
    s_nop 1
    s_cbranch_vccnz L_rare1_10
L_back1_11:
    v_exp_f32 v80, v80
    v_exp_f32 v81, v81
    v_exp_f32 v82, v82
    v_exp_f32 v83, v83
    v_exp_f32 v84, v84
    v_exp_f32 v85, v85
    v_exp_f32 v86, v86
    v_exp_f32 v87, v87
    s_cmp_lg_u32 s68, 0
    s_cbranch_scc1 L_rare2_12
L_back2_13:
    s_waitcnt lgkmcnt(0) vmcnt(4)
    s_barrier
    v_mfma_f32_32x32x16_bf16 v[64:79], v[96:99], v[160:163], v[32:47]
    s_add_u32 m0, s65, 8192
    s_nop 0
    buffer_load_dwordx4 v2, s[24:27], s99 offen offset:0 nt lds
    ds_read_b64_tr_b16 v[136:137], v22 offset:32768
    ds_read_b64_tr_b16 v[138:139], v22 offset:34816
    ds_read_b64_tr_b16 v[140:141], v23 offset:32768
    v_mfma_f32_32x32x16_bf16 v[64:79], v[100:103], v[164:167], v[64:79]
    ds_read_b64_tr_b16 v[142:143], v23 offset:34816
    ds_read_b64_tr_b16 v[128:129], v20 offset:32768
    ds_read_b64_tr_b16 v[130:131], v20 offset:34816
    v_mfma_f32_32x32x16_bf16 v[64:79], v[104:107], v[168:171], v[64:79]
    ds_read_b64_tr_b16 v[132:133], v21 offset:32768
    ds_read_b64_tr_b16 v[134:135], v21 offset:34816
    v_mfma_f32_32x32x16_bf16 v[64:79], v[108:111], v[172:175], v[64:79]
    ds_read_b64_tr_b16 v[152:153], v22 offset:36864
    ds_read_b64_tr_b16 v[154:155], v22 offset:38912
    ds_read_b64_tr_b16 v[156:157], v23 offset:36864
    v_mfma_f32_32x32x16_bf16 v[64:79], v[112:115], v[176:179], v[64:79]
    buffer_load_dwordx4 v3, s[24:27], s99 offen offset:1024 nt lds
    ds_read_b64_tr_b16 v[158:159], v23 offset:38912
    ds_read_b64_tr_b16 v[144:145], v20 offset:36864
    ds_read_b64_tr_b16 v[146:147], v20 offset:38912
    v_mfma_f32_32x32x16_bf16 v[64:79], v[116:119], v[180:183], v[64:79]
    ds_read_b64_tr_b16 v[148:149], v21 offset:36864
    ds_read_b64_tr_b16 v[150:151], v21 offset:38912
    v_mfma_f32_32x32x16_bf16 v[64:79], v[120:123], v[184:187], v[64:79]
    v_mfma_f32_32x32x16_bf16 v[64:79], v[124:127], v[188:191], v[64:79]
    v_exp_f32 v88, v88
    v_exp_f32 v89, v89
    v_exp_f32 v90, v90
    v_exp_f32 v91, v91
    v_exp_f32 v92, v92
    v_exp_f32 v93, v93
    v_exp_f32 v94, v94
    v_exp_f32 v95, v95
    v_pk_add_f32 v[26:27], v[26:27], v[80:81]
    v_cvt_pk_bf16_f32 v56, v80, v81
    v_pk_add_f32 v[26:27], v[26:27], v[82:83]
    v_cvt_pk_bf16_f32 v57, v82, v83
    v_pk_add_f32 v[26:27], v[26:27], v[84:85]
    v_cvt_pk_bf16_f32 v58, v84, v85
    v_pk_add_f32 v[26:27], v[26:27], v[86:87]
    v_cvt_pk_bf16_f32 v59, v86, v87
    v_pk_add_f32 v[26:27], v[26:27], v[88:89]
    v_cvt_pk_bf16_f32 v60, v88, v89
    v_pk_add_f32 v[26:27], v[26:27], v[90:91]
    v_cvt_pk_bf16_f32 v61, v90, v91
    s_waitcnt lgkmcnt(0)
    v_mfma_f32_32x32x16_bf16 v[224:239], v[136:139], v[56:59], v[224:239]
    s_add_u32 m0, s65, 0
    s_nop 0
    buffer_load_dwordx4 v6, s[28:31], s97 offen offset:0 nt lds
    v_pk_add_f32 v[26:27], v[26:27], v[92:93]
    v_cvt_pk_bf16_f32 v62, v92, v93
    ds_read_b128 v[96:99], v8 offset:40960
    ds_read_b128 v[100:103], v9 offset:40960
    v_mfma_f32_32x32x16_bf16 v[240:255], v[140:143], v[56:59], v[240:255]
    v_pk_add_f32 v[26:27], v[26:27], v[94:95]
    v_cvt_pk_bf16_f32 v63, v94, v95
    ds_read_b128 v[104:107], v10 offset:40960
    v_mfma_f32_32x32x16_bf16 v[192:207], v[128:131], v[56:59], v[192:207]
    ds_read_b128 v[108:111], v11 offset:40960
    v_mfma_f32_32x32x16_bf16 v[208:223], v[132:135], v[56:59], v[208:223]
    ds_read_b128 v[112:115], v12 offset:40960
    ds_read_b128 v[116:119], v13 offset:40960
    v_mfma_f32_32x32x16_bf16 v[224:239], v[152:155], v[60:63], v[224:239]
    buffer_load_dwordx4 v6, s[28:31], s97 offen offset:1024 nt lds
    ds_read_b128 v[120:123], v14 offset:40960
    v_mfma_f32_32x32x16_bf16 v[240:255], v[156:159], v[60:63], v[240:255]
    ds_read_b128 v[124:127], v15 offset:40960
    v_mfma_f32_32x32x16_bf16 v[192:207], v[144:147], v[60:63], v[192:207]
    v_mfma_f32_32x32x16_bf16 v[208:223], v[148:151], v[60:63], v[208:223]
    v_max3_f32 v28, v64, v65, v66
    v_max3_f32 v28, v28, v67, v68
    v_max3_f32 v28, v28, v69, v70
    v_max3_f32 v28, v28, v71, v72
    v_max3_f32 v28, v28, v73, v74
    v_max3_f32 v28, v28, v75, v76
    v_max3_f32 v28, v28, v77, v78
    v_max_f32 v28, v28, v79
    v_cmp_lt_f32 vcc, s67, v28
    s_nop 1
    s_cbranch_vccnz L_rare1_14
L_back1_15:
    v_exp_f32 v64, v64
    v_exp_f32 v65, v65
    v_exp_f32 v66, v66
    v_exp_f32 v67, v67
    v_exp_f32 v68, v68
    v_exp_f32 v69, v69
    v_exp_f32 v70, v70
    v_exp_f32 v71, v71
    s_cmp_lg_u32 s68, 0
    s_cbranch_scc1 L_rare2_16
L_back2_17:
    s_waitcnt lgkmcnt(0) vmcnt(4)
    s_barrier
    v_mfma_f32_32x32x16_bf16 v[80:95], v[96:99], v[160:163], v[32:47]
    s_add_u32 m0, s65, 24576
    s_nop 0
    buffer_load_dwordx4 v2, s[24:27], s100 offen offset:0 nt lds
    ds_read_b64_tr_b16 v[136:137], v22 offset:49152
    ds_read_b64_tr_b16 v[138:139], v22 offset:51200
    ds_read_b64_tr_b16 v[140:141], v23 offset:49152
    v_mfma_f32_32x32x16_bf16 v[80:95], v[100:103], v[164:167], v[80:95]
    ds_read_b64_tr_b16 v[142:143], v23 offset:51200
    ds_read_b64_tr_b16 v[128:129], v20 offset:49152
    ds_read_b64_tr_b16 v[130:131], v20 offset:51200
    v_mfma_f32_32x32x16_bf16 v[80:95], v[104:107], v[168:171], v[80:95]
    ds_read_b64_tr_b16 v[132:133], v21 offset:49152
    ds_read_b64_tr_b16 v[134:135], v21 offset:51200
    v_mfma_f32_32x32x16_bf16 v[80:95], v[108:111], v[172:175], v[80:95]
    ds_read_b64_tr_b16 v[152:153], v22 offset:53248
    ds_read_b64_tr_b16 v[154:155], v22 offset:55296
    ds_read_b64_tr_b16 v[156:157], v23 offset:53248
    v_mfma_f32_32x32x16_bf16 v[80:95], v[112:115], v[176:179], v[80:95]
    buffer_load_dwordx4 v3, s[24:27], s100 offen offset:1024 nt lds
    ds_read_b64_tr_b16 v[158:159], v23 offset:55296
    ds_read_b64_tr_b16 v[144:145], v20 offset:53248
    ds_read_b64_tr_b16 v[146:147], v20 offset:55296
    v_mfma_f32_32x32x16_bf16 v[80:95], v[116:119], v[180:183], v[80:95]
    ds_read_b64_tr_b16 v[148:149], v21 offset:53248
    ds_read_b64_tr_b16 v[150:151], v21 offset:55296
    v_mfma_f32_32x32x16_bf16 v[80:95], v[120:123], v[184:187], v[80:95]
    v_mfma_f32_32x32x16_bf16 v[80:95], v[124:127], v[188:191], v[80:95]
    v_exp_f32 v72, v72
    v_exp_f32 v73, v73
    v_exp_f32 v74, v74
    v_exp_f32 v75, v75
    v_exp_f32 v76, v76
    v_exp_f32 v77, v77
    v_exp_f32 v78, v78
    v_exp_f32 v79, v79
    v_pk_add_f32 v[26:27], v[26:27], v[64:65]
    v_cvt_pk_bf16_f32 v56, v64, v65
    v_pk_add_f32 v[26:27], v[26:27], v[66:67]
    v_cvt_pk_bf16_f32 v57, v66, v67
    v_pk_add_f32 v[26:27], v[26:27], v[68:69]
    v_cvt_pk_bf16_f32 v58, v68, v69
    v_pk_add_f32 v[26:27], v[26:27], v[70:71]
    v_cvt_pk_bf16_f32 v59, v70, v71
    v_pk_add_f32 v[26:27], v[26:27], v[72:73]
    v_cvt_pk_bf16_f32 v60, v72, v73
    v_pk_add_f32 v[26:27], v[26:27], v[74:75]
    v_cvt_pk_bf16_f32 v61, v74, v75
    s_waitcnt lgkmcnt(0)
    v_mfma_f32_32x32x16_bf16 v[224:239], v[136:139], v[56:59], v[224:239]
    s_add_u32 m0, s65, 16384
    s_nop 0
    buffer_load_dwordx4 v6, s[28:31], s98 offen offset:0 nt lds
    v_pk_add_f32 v[26:27], v[26:27], v[76:77]
    v_cvt_pk_bf16_f32 v62, v76, v77
    ds_read_b128 v[96:99], v8 offset:57344
    ds_read_b128 v[100:103], v9 offset:57344
    v_mfma_f32_32x32x16_bf16 v[240:255], v[140:143], v[56:59], v[240:255]
    v_pk_add_f32 v[26:27], v[26:27], v[78:79]
    v_cvt_pk_bf16_f32 v63, v78, v79
    ds_read_b128 v[104:107], v10 offset:57344
    v_mfma_f32_32x32x16_bf16 v[192:207], v[128:131], v[56:59], v[192:207]
    ds_read_b128 v[108:111], v11 offset:57344
    v_mfma_f32_32x32x16_bf16 v[208:223], v[132:135], v[56:59], v[208:223]
    ds_read_b128 v[112:115], v12 offset:57344
    ds_read_b128 v[116:119], v13 offset:57344
    v_mfma_f32_32x32x16_bf16 v[224:239], v[152:155], v[60:63], v[224:239]
    buffer_load_dwordx4 v6, s[28:31], s98 offen offset:1024 nt lds
    ds_read_b128 v[120:123], v14 offset:57344
    v_mfma_f32_32x32x16_bf16 v[240:255], v[156:159], v[60:63], v[240:255]
    ds_read_b128 v[124:127], v15 offset:57344
    v_mfma_f32_32x32x16_bf16 v[192:207], v[144:147], v[60:63], v[192:207]
    v_mfma_f32_32x32x16_bf16 v[208:223], v[148:151], v[60:63], v[208:223]
    v_max3_f32 v28, v80, v81, v82
    v_max3_f32 v28, v28, v83, v84
    v_max3_f32 v28, v28, v85, v86
    v_max3_f32 v28, v28, v87, v88
    v_max3_f32 v28, v28, v89, v90
    v_max3_f32 v28, v28, v91, v92
    v_max3_f32 v28, v28, v93, v94
    v_max_f32 v28, v28, v95
    v_cmp_lt_f32 vcc, s67, v28
    s_nop 1
    s_cbranch_vccnz L_rare1_18
L_back1_19:
    v_exp_f32 v80, v80
    v_exp_f32 v81, v81
    v_exp_f32 v82, v82
    v_exp_f32 v83, v83
    v_exp_f32 v84, v84
    v_exp_f32 v85, v85
    v_exp_f32 v86, v86
    v_exp_f32 v87, v87
    s_cmp_lg_u32 s68, 0
    s_cbranch_scc1 L_rare2_20
L_back2_21:
    s_cmp_eq_u32 s91, s58
    s_cbranch_scc1 L_ownatt
    s_waitcnt lgkmcnt(0) vmcnt(4)
    s_barrier
    v_mfma_f32_32x32x16_bf16 v[64:79], v[96:99], v[160:163], v[32:47]
    s_add_u32 m0, s65, 40960
    s_nop 0
    buffer_load_dwordx4 v2, s[24:27], s101 offen offset:0 nt lds
    ds_read_b64_tr_b16 v[136:137], v22 offset:0
    ds_read_b64_tr_b16 v[138:139], v22 offset:2048
    ds_read_b64_tr_b16 v[140:141], v23 offset:0
    v_mfma_f32_32x32x16_bf16 v[64:79], v[100:103], v[164:167], v[64:79]
    ds_read_b64_tr_b16 v[142:143], v23 offset:2048
    ds_read_b64_tr_b16 v[128:129], v20 offset:0
    ds_read_b64_tr_b16 v[130:131], v20 offset:2048
    v_mfma_f32_32x32x16_bf16 v[64:79], v[104:107], v[168:171], v[64:79]
    ds_read_b64_tr_b16 v[132:133], v21 offset:0
    ds_read_b64_tr_b16 v[134:135], v21 offset:2048
    v_mfma_f32_32x32x16_bf16 v[64:79], v[108:111], v[172:175], v[64:79]
    ds_read_b64_tr_b16 v[152:153], v22 offset:4096
    ds_read_b64_tr_b16 v[154:155], v22 offset:6144
    ds_read_b64_tr_b16 v[156:157], v23 offset:4096
    v_mfma_f32_32x32x16_bf16 v[64:79], v[112:115], v[176:179], v[64:79]
    buffer_load_dwordx4 v3, s[24:27], s101 offen offset:1024 nt lds
    ds_read_b64_tr_b16 v[158:159], v23 offset:6144
    ds_read_b64_tr_b16 v[144:145], v20 offset:4096
    ds_read_b64_tr_b16 v[146:147], v20 offset:6144
    v_mfma_f32_32x32x16_bf16 v[64:79], v[116:119], v[180:183], v[64:79]
    ds_read_b64_tr_b16 v[148:149], v21 offset:4096
    ds_read_b64_tr_b16 v[150:151], v21 offset:6144
    v_mfma_f32_32x32x16_bf16 v[64:79], v[120:123], v[184:187], v[64:79]
    v_mfma_f32_32x32x16_bf16 v[64:79], v[124:127], v[188:191], v[64:79]
    v_exp_f32 v88, v88
    v_exp_f32 v89, v89
    v_exp_f32 v90, v90
    v_exp_f32 v91, v91
    v_exp_f32 v92, v92
    v_exp_f32 v93, v93
    v_exp_f32 v94, v94
    v_exp_f32 v95, v95
    v_add_f32 v26, v26, v80
    v_add_f32 v27, v27, v81
    v_cvt_pk_bf16_f32 v56, v80, v81
    v_add_f32 v26, v26, v82
    v_add_f32 v27, v27, v83
    v_cvt_pk_bf16_f32 v57, v82, v83
    v_add_f32 v26, v26, v84
    v_add_f32 v27, v27, v85
    v_cvt_pk_bf16_f32 v58, v84, v85
    v_add_f32 v26, v26, v86
    v_add_f32 v27, v27, v87
    v_cvt_pk_bf16_f32 v59, v86, v87
    v_add_f32 v26, v26, v88
    v_add_f32 v27, v27, v89
    v_cvt_pk_bf16_f32 v60, v88, v89
    v_add_f32 v26, v26, v90
    v_add_f32 v27, v27, v91
    v_cvt_pk_bf16_f32 v61, v90, v91
    s_waitcnt lgkmcnt(0)
    v_mfma_f32_32x32x16_bf16 v[224:239], v[136:139], v[56:59], v[224:239]
    s_add_u32 m0, s65, 32768
    s_nop 0
    buffer_load_dwordx4 v6, s[28:31], s99 offen offset:0 nt lds
    v_add_f32 v26, v26, v92
    v_add_f32 v27, v27, v93
    v_cvt_pk_bf16_f32 v62, v92, v93
    ds_read_b128 v[96:99], v8 offset:8192
    ds_read_b128 v[100:103], v9 offset:8192
    v_mfma_f32_32x32x16_bf16 v[240:255], v[140:143], v[56:59], v[240:255]
    v_add_f32 v26, v26, v94
    v_add_f32 v27, v27, v95
    v_cvt_pk_bf16_f32 v63, v94, v95
    ds_read_b128 v[104:107], v10 offset:8192
    v_mfma_f32_32x32x16_bf16 v[192:207], v[128:131], v[56:59], v[192:207]
    ds_read_b128 v[108:111], v11 offset:8192
    v_mfma_f32_32x32x16_bf16 v[208:223], v[132:135], v[56:59], v[208:223]
    ds_read_b128 v[112:115], v12 offset:8192
    ds_read_b128 v[116:119], v13 offset:8192
    v_mfma_f32_32x32x16_bf16 v[224:239], v[152:155], v[60:63], v[224:239]
    buffer_load_dwordx4 v6, s[28:31], s99 offen offset:1024 nt lds
    ds_read_b128 v[120:123], v14 offset:8192
    v_mfma_f32_32x32x16_bf16 v[240:255], v[156:159], v[60:63], v[240:255]
    ds_read_b128 v[124:127], v15 offset:8192
    v_mfma_f32_32x32x16_bf16 v[192:207], v[144:147], v[60:63], v[192:207]
    v_mfma_f32_32x32x16_bf16 v[208:223], v[148:151], v[60:63], v[208:223]
    v_max3_f32 v28, v64, v65, v66
    v_max3_f32 v28, v28, v67, v68
    v_max3_f32 v28, v28, v69, v70
    v_max3_f32 v28, v28, v71, v72
    v_max3_f32 v28, v28, v73, v74
    v_max3_f32 v28, v28, v75, v76
    v_max3_f32 v28, v28, v77, v78
    v_max_f32 v28, v28, v79
    v_cmp_lt_f32 vcc, s67, v28
    s_nop 1
    s_cbranch_vccnz L_rare1_22
L_back1_23:
    v_exp_f32 v64, v64
    v_exp_f32 v65, v65
    v_exp_f32 v66, v66
    v_exp_f32 v67, v67
    v_exp_f32 v68, v68
    v_exp_f32 v69, v69
    v_exp_f32 v70, v70
    v_exp_f32 v71, v71
    s_cmp_lg_u32 s68, 0
    s_cbranch_scc1 L_rare2_24
L_back2_25:
    s_waitcnt lgkmcnt(0) vmcnt(4)
    s_barrier
    v_mfma_f32_32x32x16_bf16 v[80:95], v[96:99], v[160:163], v[32:47]
    s_add_u32 m0, s65, 49152
    s_nop 0
    buffer_load_dwordx4 v6, s[28:31], s100 offen offset:0 nt lds
    ds_read_b64_tr_b16 v[136:137], v22 offset:16384
    ds_read_b64_tr_b16 v[138:139], v22 offset:18432
    ds_read_b64_tr_b16 v[140:141], v23 offset:16384
    v_exp_f32 v72, v72
    v_exp_f32 v73, v73
    v_exp_f32 v74, v74
    v_exp_f32 v75, v75
    v_mfma_f32_32x32x16_bf16 v[80:95], v[100:103], v[164:167], v[80:95]
    ds_read_b64_tr_b16 v[142:143], v23 offset:18432
    ds_read_b64_tr_b16 v[128:129], v20 offset:16384
    ds_read_b64_tr_b16 v[130:131], v20 offset:18432
    v_exp_f32 v76, v76
    v_exp_f32 v77, v77
    v_exp_f32 v78, v78
    v_mfma_f32_32x32x16_bf16 v[80:95], v[104:107], v[168:171], v[80:95]
    ds_read_b64_tr_b16 v[132:133], v21 offset:16384
    ds_read_b64_tr_b16 v[134:135], v21 offset:18432
    v_exp_f32 v79, v79
    v_add_f32 v26, v26, v64
    v_add_f32 v27, v27, v65
    v_mfma_f32_32x32x16_bf16 v[80:95], v[108:111], v[172:175], v[80:95]
    ds_read_b64_tr_b16 v[152:153], v22 offset:20480
    ds_read_b64_tr_b16 v[154:155], v22 offset:22528
    ds_read_b64_tr_b16 v[156:157], v23 offset:20480
    v_cvt_pk_bf16_f32 v56, v64, v65
    v_add_f32 v26, v26, v66
    v_add_f32 v27, v27, v67
    v_mfma_f32_32x32x16_bf16 v[80:95], v[112:115], v[176:179], v[80:95]
    buffer_load_dwordx4 v6, s[28:31], s100 offen offset:1024 nt lds
    ds_read_b64_tr_b16 v[158:159], v23 offset:22528
    ds_read_b64_tr_b16 v[144:145], v20 offset:20480
    ds_read_b64_tr_b16 v[146:147], v20 offset:22528
    v_cvt_pk_bf16_f32 v57, v66, v67
    v_add_f32 v26, v26, v68
    v_add_f32 v27, v27, v69
    v_cvt_pk_bf16_f32 v58, v68, v69
    v_mfma_f32_32x32x16_bf16 v[80:95], v[116:119], v[180:183], v[80:95]
    ds_read_b64_tr_b16 v[148:149], v21 offset:20480
    ds_read_b64_tr_b16 v[150:151], v21 offset:22528
    v_add_f32 v26, v26, v70
    v_add_f32 v27, v27, v71
    v_cvt_pk_bf16_f32 v59, v70, v71
    v_mfma_f32_32x32x16_bf16 v[80:95], v[120:123], v[184:187], v[80:95]
    v_add_f32 v26, v26, v72
    v_add_f32 v27, v27, v73
    v_cvt_pk_bf16_f32 v60, v72, v73
    v_mfma_f32_32x32x16_bf16 v[80:95], v[124:127], v[188:191], v[80:95]
    v_add_f32 v26, v26, v74
    v_add_f32 v27, v27, v75
    v_cvt_pk_bf16_f32 v61, v74, v75
    s_waitcnt lgkmcnt(0)
    v_mfma_f32_32x32x16_bf16 v[224:239], v[136:139], v[56:59], v[224:239]
    s_add_u32 m0, s65, 57344
    s_nop 0
    buffer_load_dwordx4 v6, s[28:31], s101 offen offset:0 nt lds
    v_add_f32 v26, v26, v76
    v_add_f32 v27, v27, v77
    v_cvt_pk_bf16_f32 v62, v76, v77
    ds_read_b128 v[96:99], v8 offset:24576
    ds_read_b128 v[100:103], v9 offset:24576
    v_mfma_f32_32x32x16_bf16 v[240:255], v[140:143], v[56:59], v[240:255]
    v_add_f32 v26, v26, v78
    v_add_f32 v27, v27, v79
    v_cvt_pk_bf16_f32 v63, v78, v79
    ds_read_b128 v[104:107], v10 offset:24576
    v_max3_f32 v28, v80, v81, v82
    v_max3_f32 v28, v28, v83, v84
    v_max3_f32 v28, v28, v85, v86
    v_mfma_f32_32x32x16_bf16 v[192:207], v[128:131], v[56:59], v[192:207]
    ds_read_b128 v[108:111], v11 offset:24576
    v_max3_f32 v28, v28, v87, v88
    v_max3_f32 v28, v28, v89, v90
    v_max3_f32 v28, v28, v91, v92
    v_mfma_f32_32x32x16_bf16 v[208:223], v[132:135], v[56:59], v[208:223]
    ds_read_b128 v[112:115], v12 offset:24576
    ds_read_b128 v[116:119], v13 offset:24576
    v_max3_f32 v28, v28, v93, v94
    v_max_f32 v28, v28, v95
    v_cmp_lt_f32 vcc, s67, v28
    v_mfma_f32_32x32x16_bf16 v[224:239], v[152:155], v[60:63], v[224:239]
    buffer_load_dwordx4 v6, s[28:31], s101 offen offset:1024 nt lds
    ds_read_b128 v[120:123], v14 offset:24576
    s_cbranch_vccnz L_rare1_26
L_back1_27:
    v_exp_f32 v80, v80
    v_exp_f32 v81, v81
    v_mfma_f32_32x32x16_bf16 v[240:255], v[156:159], v[60:63], v[240:255]
    ds_read_b128 v[124:127], v15 offset:24576
    v_exp_f32 v82, v82
    v_exp_f32 v83, v83
    v_exp_f32 v84, v84
    v_mfma_f32_32x32x16_bf16 v[192:207], v[144:147], v[60:63], v[192:207]
    v_exp_f32 v85, v85
    v_exp_f32 v86, v86
    v_exp_f32 v87, v87
    v_mfma_f32_32x32x16_bf16 v[208:223], v[148:151], v[60:63], v[208:223]
    s_cmp_lg_u32 s68, 0
    s_cbranch_scc1 L_rare2_28
L_back2_29:
    s_waitcnt lgkmcnt(0) vmcnt(4)
    s_barrier
    v_mfma_f32_32x32x16_bf16 v[64:79], v[96:99], v[160:163], v[32:47]
    buffer_load_dword v31, v19, s[36:39], s83 offen
    ds_read_b64_tr_b16 v[136:137], v22 offset:32768
    ds_read_b64_tr_b16 v[138:139], v22 offset:34816
    ds_read_b64_tr_b16 v[140:141], v23 offset:32768
    v_exp_f32 v88, v88
    v_exp_f32 v89, v89
    v_exp_f32 v90, v90
    v_exp_f32 v91, v91
    v_mfma_f32_32x32x16_bf16 v[64:79], v[100:103], v[164:167], v[64:79]
    ds_read_b64_tr_b16 v[142:143], v23 offset:34816
    ds_read_b64_tr_b16 v[128:129], v20 offset:32768
    ds_read_b64_tr_b16 v[130:131], v20 offset:34816
    v_exp_f32 v92, v92
    v_exp_f32 v93, v93
    v_exp_f32 v94, v94
    v_mfma_f32_32x32x16_bf16 v[64:79], v[104:107], v[168:171], v[64:79]
    ds_read_b64_tr_b16 v[132:133], v21 offset:32768
    ds_read_b64_tr_b16 v[134:135], v21 offset:34816
    v_exp_f32 v95, v95
    v_add_f32 v26, v26, v80
    v_add_f32 v27, v27, v81
    v_mfma_f32_32x32x16_bf16 v[64:79], v[108:111], v[172:175], v[64:79]
    ds_read_b64_tr_b16 v[152:153], v22 offset:36864
    ds_read_b64_tr_b16 v[154:155], v22 offset:38912
    ds_read_b64_tr_b16 v[156:157], v23 offset:36864
    v_cvt_pk_bf16_f32 v56, v80, v81
    v_add_f32 v26, v26, v82
    v_add_f32 v27, v27, v83
    v_mfma_f32_32x32x16_bf16 v[64:79], v[112:115], v[176:179], v[64:79]
    ds_read_b64_tr_b16 v[158:159], v23 offset:38912
    ds_read_b64_tr_b16 v[144:145], v20 offset:36864
    ds_read_b64_tr_b16 v[146:147], v20 offset:38912
    v_cvt_pk_bf16_f32 v57, v82, v83
    v_add_f32 v26, v26, v84
    v_add_f32 v27, v27, v85
    v_cvt_pk_bf16_f32 v58, v84, v85
    v_mfma_f32_32x32x16_bf16 v[64:79], v[116:119], v[180:183], v[64:79]
    ds_read_b64_tr_b16 v[148:149], v21 offset:36864
    ds_read_b64_tr_b16 v[150:151], v21 offset:38912
    v_add_f32 v26, v26, v86
    v_add_f32 v27, v27, v87
    v_cvt_pk_bf16_f32 v59, v86, v87
    v_mfma_f32_32x32x16_bf16 v[64:79], v[120:123], v[184:187], v[64:79]
    v_add_f32 v26, v26, v88
    v_add_f32 v27, v27, v89
    v_cvt_pk_bf16_f32 v60, v88, v89
    v_mfma_f32_32x32x16_bf16 v[64:79], v[124:127], v[188:191], v[64:79]
    v_add_f32 v26, v26, v90
    v_add_f32 v27, v27, v91
    v_cvt_pk_bf16_f32 v61, v90, v91
    s_waitcnt lgkmcnt(0)
    v_mfma_f32_32x32x16_bf16 v[224:239], v[136:139], v[56:59], v[224:239]
    v_add_f32 v26, v26, v92
    v_add_f32 v27, v27, v93
    v_cvt_pk_bf16_f32 v62, v92, v93
    ds_read_b128 v[96:99], v8 offset:40960
    ds_read_b128 v[100:103], v9 offset:40960
    v_mfma_f32_32x32x16_bf16 v[240:255], v[140:143], v[56:59], v[240:255]
    v_add_f32 v26, v26, v94
    v_add_f32 v27, v27, v95
    v_cvt_pk_bf16_f32 v63, v94, v95
    ds_read_b128 v[104:107], v10 offset:40960
    v_max3_f32 v28, v64, v65, v66
    v_max3_f32 v28, v28, v67, v68
    v_max3_f32 v28, v28, v69, v70
    v_mfma_f32_32x32x16_bf16 v[192:207], v[128:131], v[56:59], v[192:207]
    ds_read_b128 v[108:111], v11 offset:40960
    v_max3_f32 v28, v28, v71, v72
    v_max3_f32 v28, v28, v73, v74
    v_max3_f32 v28, v28, v75, v76
    v_mfma_f32_32x32x16_bf16 v[208:223], v[132:135], v[56:59], v[208:223]
    ds_read_b128 v[112:115], v12 offset:40960
    ds_read_b128 v[116:119], v13 offset:40960
    v_max3_f32 v28, v28, v77, v78
    v_max_f32 v28, v28, v79
    v_cmp_lt_f32 vcc, s67, v28
    v_mfma_f32_32x32x16_bf16 v[224:239], v[152:155], v[60:63], v[224:239]
    ds_read_b128 v[120:123], v14 offset:40960
    s_cbranch_vccnz L_rare1_30
L_back1_31:
    v_exp_f32 v64, v64
    v_exp_f32 v65, v65
    v_mfma_f32_32x32x16_bf16 v[240:255], v[156:159], v[60:63], v[240:255]
    ds_read_b128 v[124:127], v15 offset:40960
    v_exp_f32 v66, v66
    v_exp_f32 v67, v67
    v_exp_f32 v68, v68
    v_mfma_f32_32x32x16_bf16 v[192:207], v[144:147], v[60:63], v[192:207]
    v_exp_f32 v69, v69
    v_exp_f32 v70, v70
    v_exp_f32 v71, v71
    v_mfma_f32_32x32x16_bf16 v[208:223], v[148:151], v[60:63], v[208:223]
    s_cmp_lg_u32 s68, 0
    s_cbranch_scc1 L_rare2_32
L_back2_33:
    s_waitcnt lgkmcnt(0) vmcnt(1)
    s_barrier
    v_mfma_f32_32x32x16_bf16 v[80:95], v[96:99], v[160:163], v[32:47]
    ds_read_b64_tr_b16 v[136:137], v22 offset:49152
    ds_read_b64_tr_b16 v[138:139], v22 offset:51200
    ds_read_b64_tr_b16 v[140:141], v23 offset:49152
    v_exp_f32 v72, v72
    v_exp_f32 v73, v73
    v_exp_f32 v74, v74
    v_exp_f32 v75, v75
    v_lshrrev_b32 v13, 4, v1
    v_and_b32 v14, 15, v1
    v_xor_b32 v8, s71, v14
    v_lshlrev_b32 v8, 4, v8
    v_lshl_add_u32 v8, v13, 14, v8
    v_mfma_f32_32x32x16_bf16 v[80:95], v[100:103], v[164:167], v[80:95]
    ds_read_b64_tr_b16 v[142:143], v23 offset:51200
    ds_read_b64_tr_b16 v[128:129], v20 offset:49152
    ds_read_b64_tr_b16 v[130:131], v20 offset:51200
    v_exp_f32 v76, v76
    v_exp_f32 v77, v77
    v_exp_f32 v78, v78
    v_mfma_f32_32x32x16_bf16 v[80:95], v[104:107], v[168:171], v[80:95]
    ds_read_b64_tr_b16 v[132:133], v21 offset:49152
    ds_read_b64_tr_b16 v[134:135], v21 offset:51200
    v_exp_f32 v79, v79
    v_add_f32 v26, v26, v64
    v_add_f32 v27, v27, v65
    v_mfma_f32_32x32x16_bf16 v[80:95], v[108:111], v[172:175], v[80:95]
    ds_read_b64_tr_b16 v[152:153], v22 offset:53248
    ds_read_b64_tr_b16 v[154:155], v22 offset:55296
    ds_read_b64_tr_b16 v[156:157], v23 offset:53248
    v_cvt_pk_bf16_f32 v56, v64, v65
    v_add_f32 v26, v26, v66
    v_add_f32 v27, v27, v67
    v_mfma_f32_32x32x16_bf16 v[80:95], v[112:115], v[176:179], v[80:95]
    ds_read_b64_tr_b16 v[158:159], v23 offset:55296
    ds_read_b64_tr_b16 v[144:145], v20 offset:53248
    ds_read_b64_tr_b16 v[146:147], v20 offset:55296
    v_cvt_pk_bf16_f32 v57, v66, v67
    v_add_f32 v26, v26, v68
    v_add_f32 v27, v27, v69
    v_cvt_pk_bf16_f32 v58, v68, v69
    v_mfma_f32_32x32x16_bf16 v[80:95], v[116:119], v[180:183], v[80:95]
    ds_read_b64_tr_b16 v[148:149], v21 offset:53248
    ds_read_b64_tr_b16 v[150:151], v21 offset:55296
    v_add_f32 v26, v26, v70
    v_add_f32 v27, v27, v71
    v_cvt_pk_bf16_f32 v59, v70, v71
    v_mfma_f32_32x32x16_bf16 v[80:95], v[120:123], v[184:187], v[80:95]
    v_add_f32 v26, v26, v72
    v_add_f32 v27, v27, v73
    v_cvt_pk_bf16_f32 v60, v72, v73
    v_mfma_f32_32x32x16_bf16 v[80:95], v[124:127], v[188:191], v[80:95]
    v_add_f32 v26, v26, v74
    v_add_f32 v27, v27, v75
    v_cvt_pk_bf16_f32 v61, v74, v75
    s_waitcnt lgkmcnt(0)
    v_mfma_f32_32x32x16_bf16 v[224:239], v[136:139], v[56:59], v[224:239]
    v_add_f32 v26, v26, v76
    v_add_f32 v27, v27, v77
    v_cvt_pk_bf16_f32 v62, v76, v77
    ds_read_b64_tr_b16 v[104:105], v22 offset:57344
    ds_read_b64_tr_b16 v[106:107], v22 offset:59392
    ds_read_b64_tr_b16 v[108:109], v23 offset:57344
    s_lshl_b32 s75, s84, 16
    s_add_u32 s75, s75, s82
    buffer_load_dwordx4 v[160:163], v8, s[36:39], s75 offen offset:0
    v_mfma_f32_32x32x16_bf16 v[240:255], v[140:143], v[56:59], v[240:255]
    v_add_f32 v26, v26, v78
    v_add_f32 v27, v27, v79
    v_cvt_pk_bf16_f32 v63, v78, v79
    ds_read_b64_tr_b16 v[110:111], v23 offset:59392
    ds_read_b64_tr_b16 v[96:97], v20 offset:57344
    ds_read_b64_tr_b16 v[98:99], v20 offset:59392
    v_max3_f32 v28, v80, v81, v82
    v_max3_f32 v28, v28, v83, v84
    v_max3_f32 v28, v28, v85, v86
    v_max3_f32 v28, v28, v87, v88
    buffer_load_dwordx4 v[164:167], v8, s[36:39], s75 offen offset:2048
    v_mfma_f32_32x32x16_bf16 v[192:207], v[128:131], v[56:59], v[192:207]
    ds_read_b64_tr_b16 v[100:101], v21 offset:57344
    ds_read_b64_tr_b16 v[102:103], v21 offset:59392
    v_max3_f32 v28, v28, v89, v90
    v_max3_f32 v28, v28, v91, v92
    v_max3_f32 v28, v28, v93, v94
    v_max_f32 v28, v28, v95
    s_add_u32 s75, s75, 4096
    buffer_load_dwordx4 v[168:171], v8, s[36:39], s75 offen offset:0
    v_mfma_f32_32x32x16_bf16 v[208:223], v[132:135], v[56:59], v[208:223]
    ds_read_b64_tr_b16 v[120:121], v22 offset:61440
    ds_read_b64_tr_b16 v[122:123], v22 offset:63488
    ds_read_b64_tr_b16 v[124:125], v23 offset:61440
    v_cmp_lt_f32 vcc, s67, v28
    s_nop 1
    s_cbranch_vccnz L_rare1_34
L_back1_35:
    v_exp_f32 v80, v80
    buffer_load_dwordx4 v[172:175], v8, s[36:39], s75 offen offset:2048
    v_mfma_f32_32x32x16_bf16 v[224:239], v[152:155], v[60:63], v[224:239]
    ds_read_b64_tr_b16 v[126:127], v23 offset:63488
    ds_read_b64_tr_b16 v[112:113], v20 offset:61440
    ds_read_b64_tr_b16 v[114:115], v20 offset:63488
    v_exp_f32 v81, v81
    v_exp_f32 v82, v82
    v_exp_f32 v83, v83
    v_exp_f32 v84, v84
    s_add_u32 s75, s75, 4096
    buffer_load_dwordx4 v[176:179], v8, s[36:39], s75 offen offset:0
    v_mfma_f32_32x32x16_bf16 v[240:255], v[156:159], v[60:63], v[240:255]
    ds_read_b64_tr_b16 v[116:117], v21 offset:61440
    ds_read_b64_tr_b16 v[118:119], v21 offset:63488
    v_exp_f32 v85, v85
    v_exp_f32 v86, v86
    v_exp_f32 v87, v87
    v_exp_f32 v88, v88
    buffer_load_dwordx4 v[180:183], v8, s[36:39], s75 offen offset:2048
    v_mfma_f32_32x32x16_bf16 v[192:207], v[144:147], v[60:63], v[192:207]
    v_exp_f32 v89, v89
    v_exp_f32 v90, v90
    v_exp_f32 v91, v91
    v_mfma_f32_32x32x16_bf16 v[208:223], v[148:151], v[60:63], v[208:223]
    v_add_f32 v26, v26, v80
    v_add_f32 v27, v27, v81
    v_cvt_pk_bf16_f32 v56, v80, v81
    v_add_f32 v26, v26, v82
    v_add_f32 v27, v27, v83
    v_cvt_pk_bf16_f32 v57, v82, v83
    v_add_f32 v26, v26, v84
    v_add_f32 v27, v27, v85
    v_cvt_pk_bf16_f32 v58, v84, v85
    v_add_f32 v26, v26, v86
    v_add_f32 v27, v27, v87
    v_cvt_pk_bf16_f32 v59, v86, v87
    s_cmp_lg_u32 s68, 0
    s_cbranch_scc1 L_rare2_36
L_back2_37:
    s_waitcnt lgkmcnt(0)
    v_mfma_f32_32x32x16_bf16 v[224:239], v[104:107], v[56:59], v[224:239]
    v_exp_f32 v92, v92
    v_exp_f32 v93, v93
    v_exp_f32 v94, v94
    v_exp_f32 v95, v95
    v_mfma_f32_32x32x16_bf16 v[240:255], v[108:111], v[56:59], v[240:255]
    v_add_f32 v26, v26, v88
    v_add_f32 v27, v27, v89
    v_cvt_pk_bf16_f32 v60, v88, v89
    v_add_f32 v26, v26, v90
    v_mfma_f32_32x32x16_bf16 v[192:207], v[96:99], v[56:59], v[192:207]
    v_add_f32 v27, v27, v91
    v_cvt_pk_bf16_f32 v61, v90, v91
    v_add_f32 v26, v26, v92
    v_add_f32 v27, v27, v93
    v_mfma_f32_32x32x16_bf16 v[208:223], v[100:103], v[56:59], v[208:223]
    v_cvt_pk_bf16_f32 v62, v92, v93
    v_add_f32 v26, v26, v94
    v_add_f32 v27, v27, v95
    v_cvt_pk_bf16_f32 v63, v94, v95
    s_barrier
    s_nop 0
    v_mfma_f32_32x32x16_bf16 v[224:239], v[120:123], v[60:63], v[224:239]
    v_add_f32 v25, v27, v26
    v_mov_b32 v29, v25
    v_lshlrev_b32 v15, 4, v1
    s_sub_u32 s72, s91, s58
    s_sub_u32 s72, s72, 1
    v_permlane32_swap_b32 v29, v25
    s_and_b32 s72, s72, 3
    s_lshl_b32 s73, s72, 1
    s_add_u32 s73, s73, 1
    s_cmp_eq_u32 s72, 3
    s_cselect_b32 s72, 8, s73
    s_lshl_b32 s72, s72, 13
    s_mul_i32 s73, s64, 81920
    v_mfma_f32_32x32x16_bf16 v[240:255], v[124:127], v[60:63], v[240:255]
    s_sub_u32 s76, 81920, s73
    v_add_f32 v25, v25, v29
    s_add_u32 s74, s72, s73
    v_add_u32 v45, s74, v15
    s_add_u32 s74, s72, s76
    v_add_u32 v40, s74, v15
    v_lshlrev_b32 v46, 3, v1
    s_lshl_b32 s72, s91, 9
    s_add_u32 s72, s72, 73728
    s_add_u32 s74, s72, s73
    v_add_u32 v47, s74, v46
    s_add_u32 s74, s72, s76
    v_add_u32 v41, s74, v46
    v_mfma_f32_32x32x16_bf16 v[192:207], v[112:115], v[60:63], v[192:207]
    ds_write_b64 v47, v[24:25]
    s_lshl_b32 s73, s3, 13
    s_add_u32 s73, s73, 4194304
    s_lshl_b32 s76, s64, 12
    s_add_u32 s73, s73, s76
    s_lshl_b32 s72, s3, 8
    s_add_u32 s72, s72, 131072
    s_lshr_b32 s74, s3, 4
    s_lshl_b32 s74, s74, 2
    s_add_u32 s74, s74, s58
    s_lshl_b32 s74, s74, 10
    s_add_u32 s74, s74, 655360
    s_lshl_b32 s76, s91, 1
    v_mfma_f32_32x32x16_bf16 v[208:223], v[116:119], v[60:63], v[208:223]
    s_add_u32 s76, s76, s64
    s_lshl_b32 s76, s76, 7
    s_add_u32 s74, s74, s76
    v_lshlrev_b32 v44, 4, v14
    v_bfe_u32 v42, v1, 4, 1
    v_lshl_add_u32 v44, v42, 10, v44
    v_lshrrev_b32 v42, 5, v1
    v_lshl_add_u32 v44, v42, 8, v44
    s_lshl_b32 s75, s84, 16
    s_add_u32 s75, s75, s82
    s_add_u32 s75, s75, 12288
    buffer_load_dwordx4 v[184:187], v8, s[36:39], s75 offen offset:0
    buffer_load_dwordx4 v[188:191], v8, s[36:39], s75 offen offset:2048
    s_lshl_b32 s75, s85, 16
    s_add_u32 s75, s75, s82
    buffer_load_dwordx4 v[128:131], v8, s[36:39], s75 offen offset:0
    buffer_load_dwordx4 v[132:135], v8, s[36:39], s75 offen offset:2048
    s_add_u32 s75, s75, 4096
    buffer_load_dwordx4 v[136:139], v8, s[36:39], s75 offen offset:0
    buffer_load_dwordx4 v[140:143], v8, s[36:39], s75 offen offset:2048
    ds_write_b128 v45, v[224:227] offset:0
    ds_write_b128 v45, v[228:231] offset:1024
    ds_write_b128 v45, v[232:235] offset:2048
    ds_write_b128 v45, v[236:239] offset:3072
    ds_write_b128 v45, v[240:243] offset:4096
    ds_write_b128 v45, v[244:247] offset:5120
    ds_write_b128 v45, v[248:251] offset:6144
    ds_write_b128 v45, v[252:255] offset:7168
    s_waitcnt lgkmcnt(0)
    s_barrier
    ds_read_b64 v[34:35], v41
    ds_read_b128 v[224:227], v40 offset:0
    ds_read_b128 v[228:231], v40 offset:1024
    ds_read_b128 v[232:235], v40 offset:2048
    ds_read_b128 v[236:239], v40 offset:3072
    ds_read_b128 v[240:243], v40 offset:4096
    ds_read_b128 v[244:247], v40 offset:5120
    ds_read_b128 v[248:251], v40 offset:6144
    ds_read_b128 v[252:255], v40 offset:7168
    s_waitcnt lgkmcnt(8)
    v_max_f32 v32, v24, v34
    v_sub_f32 v40, v24, v32
    v_sub_f32 v41, v34, v32
    v_exp_f32 v40, v40
    v_exp_f32 v41, v41
    s_nop 0
    v_pk_mul_f32 v[192:193], v[192:193], v[40:41] op_sel:[0,0] op_sel_hi:[1,0]
    v_pk_mul_f32 v[194:195], v[194:195], v[40:41] op_sel:[0,0] op_sel_hi:[1,0]
    v_pk_mul_f32 v[196:197], v[196:197], v[40:41] op_sel:[0,0] op_sel_hi:[1,0]
    v_pk_mul_f32 v[198:199], v[198:199], v[40:41] op_sel:[0,0] op_sel_hi:[1,0]
    v_pk_mul_f32 v[200:201], v[200:201], v[40:41] op_sel:[0,0] op_sel_hi:[1,0]
    v_pk_mul_f32 v[202:203], v[202:203], v[40:41] op_sel:[0,0] op_sel_hi:[1,0]
    v_pk_mul_f32 v[204:205], v[204:205], v[40:41] op_sel:[0,0] op_sel_hi:[1,0]
    v_pk_mul_f32 v[206:207], v[206:207], v[40:41] op_sel:[0,0] op_sel_hi:[1,0]
    v_pk_mul_f32 v[208:209], v[208:209], v[40:41] op_sel:[0,0] op_sel_hi:[1,0]
    v_pk_mul_f32 v[210:211], v[210:211], v[40:41] op_sel:[0,0] op_sel_hi:[1,0]
    v_pk_mul_f32 v[212:213], v[212:213], v[40:41] op_sel:[0,0] op_sel_hi:[1,0]
    v_pk_mul_f32 v[214:215], v[214:215], v[40:41] op_sel:[0,0] op_sel_hi:[1,0]
    v_pk_mul_f32 v[216:217], v[216:217], v[40:41] op_sel:[0,0] op_sel_hi:[1,0]
    v_pk_mul_f32 v[218:219], v[218:219], v[40:41] op_sel:[0,0] op_sel_hi:[1,0]
    v_pk_mul_f32 v[220:221], v[220:221], v[40:41] op_sel:[0,0] op_sel_hi:[1,0]
    v_pk_mul_f32 v[222:223], v[222:223], v[40:41] op_sel:[0,0] op_sel_hi:[1,0]
    v_mul_f32 v33, v25, v40
    v_fmac_f32 v33, v35, v41
    s_waitcnt lgkmcnt(4)
    v_pk_fma_f32 v[192:193], v[224:225], v[40:41], v[192:193] op_sel:[0,1,0] op_sel_hi:[1,1,1]
    v_pk_fma_f32 v[194:195], v[226:227], v[40:41], v[194:195] op_sel:[0,1,0] op_sel_hi:[1,1,1]
    v_pk_fma_f32 v[196:197], v[228:229], v[40:41], v[196:197] op_sel:[0,1,0] op_sel_hi:[1,1,1]
    v_pk_fma_f32 v[198:199], v[230:231], v[40:41], v[198:199] op_sel:[0,1,0] op_sel_hi:[1,1,1]
    v_pk_fma_f32 v[200:201], v[232:233], v[40:41], v[200:201] op_sel:[0,1,0] op_sel_hi:[1,1,1]
    v_pk_fma_f32 v[202:203], v[234:235], v[40:41], v[202:203] op_sel:[0,1,0] op_sel_hi:[1,1,1]
    v_pk_fma_f32 v[204:205], v[236:237], v[40:41], v[204:205] op_sel:[0,1,0] op_sel_hi:[1,1,1]
    v_pk_fma_f32 v[206:207], v[238:239], v[40:41], v[206:207] op_sel:[0,1,0] op_sel_hi:[1,1,1]
    v_cvt_pk_bf16_f32 v64, v192, v193
    v_cvt_pk_bf16_f32 v65, v194, v195
    v_cvt_pk_bf16_f32 v66, v196, v197
    v_cvt_pk_bf16_f32 v67, v198, v199
    v_cvt_pk_bf16_f32 v68, v200, v201
    v_cvt_pk_bf16_f32 v69, v202, v203
    v_cvt_pk_bf16_f32 v70, v204, v205
    v_cvt_pk_bf16_f32 v71, v206, v207
    buffer_store_dwordx4 v[64:67], v15, s[48:51], s73 offen offset:0 sc1
    buffer_store_dwordx4 v[68:71], v15, s[48:51], s73 offen offset:1024 sc1
    s_waitcnt lgkmcnt(0)
    v_pk_fma_f32 v[208:209], v[240:241], v[40:41], v[208:209] op_sel:[0,1,0] op_sel_hi:[1,1,1]
    v_pk_fma_f32 v[210:211], v[242:243], v[40:41], v[210:211] op_sel:[0,1,0] op_sel_hi:[1,1,1]
    v_pk_fma_f32 v[212:213], v[244:245], v[40:41], v[212:213] op_sel:[0,1,0] op_sel_hi:[1,1,1]
    v_pk_fma_f32 v[214:215], v[246:247], v[40:41], v[214:215] op_sel:[0,1,0] op_sel_hi:[1,1,1]
    v_pk_fma_f32 v[216:217], v[248:249], v[40:41], v[216:217] op_sel:[0,1,0] op_sel_hi:[1,1,1]
    v_pk_fma_f32 v[218:219], v[250:251], v[40:41], v[218:219] op_sel:[0,1,0] op_sel_hi:[1,1,1]
    v_pk_fma_f32 v[220:221], v[252:253], v[40:41], v[220:221] op_sel:[0,1,0] op_sel_hi:[1,1,1]
    v_pk_fma_f32 v[222:223], v[254:255], v[40:41], v[222:223] op_sel:[0,1,0] op_sel_hi:[1,1,1]
    v_cvt_pk_bf16_f32 v72, v208, v209
    v_cvt_pk_bf16_f32 v73, v210, v211
    v_cvt_pk_bf16_f32 v74, v212, v213
    v_cvt_pk_bf16_f32 v75, v214, v215
    v_cvt_pk_bf16_f32 v76, v216, v217
    v_cvt_pk_bf16_f32 v77, v218, v219
    v_cvt_pk_bf16_f32 v78, v220, v221
    v_cvt_pk_bf16_f32 v79, v222, v223
    buffer_store_dwordx4 v[72:75], v15, s[48:51], s73 offen offset:2048 sc1
    buffer_store_dwordx4 v[76:79], v15, s[48:51], s73 offen offset:3072 sc1
    s_cmp_lg_u32 s64, 0
    s_cbranch_scc1 L_nostat_38
    s_mov_b32 exec_hi, 0
    buffer_store_dwordx2 v[32:33], v46, s[48:51], s72 offen sc1
    s_mov_b64 exec, -1
L_nostat_38:
    v_mov_b32 v28, s62
    v_mov_b32 v29, s63
    v_mov_b32 v30, 0
    s_mov_b64 exec, 1
    s_waitcnt vmcnt(0)
    buffer_store_dwordx2 v[28:29], v30, s[48:51], s74 offen sc1
    s_mov_b64 exec, -1
    s_barrier
    s_branch L_t1done_39
L_ownatt:
    s_waitcnt lgkmcnt(0) vmcnt(4)
    s_barrier
    v_mfma_f32_32x32x16_bf16 v[64:79], v[96:99], v[160:163], v[32:47]
    s_add_u32 m0, s65, 40960
    s_nop 0
    buffer_load_dwordx4 v2, s[24:27], s101 offen offset:0 nt lds
    v_mfma_f32_32x32x16_bf16 v[64:79], v[100:103], v[164:167], v[64:79]
    v_mfma_f32_32x32x16_bf16 v[64:79], v[104:107], v[168:171], v[64:79]
    v_mfma_f32_32x32x16_bf16 v[64:79], v[108:111], v[172:175], v[64:79]
    v_mfma_f32_32x32x16_bf16 v[64:79], v[112:115], v[176:179], v[64:79]
    buffer_load_dwordx4 v3, s[24:27], s101 offen offset:1024 nt lds
    v_mfma_f32_32x32x16_bf16 v[64:79], v[116:119], v[180:183], v[64:79]
    v_mfma_f32_32x32x16_bf16 v[64:79], v[120:123], v[184:187], v[64:79]
    v_mfma_f32_32x32x16_bf16 v[64:79], v[124:127], v[188:191], v[64:79]
    v_exp_f32 v88, v88
    v_exp_f32 v89, v89
    v_exp_f32 v90, v90
    v_exp_f32 v91, v91
    v_exp_f32 v92, v92
    v_exp_f32 v93, v93
    v_exp_f32 v94, v94
    v_exp_f32 v95, v95
    v_add_f32 v26, v26, v80
    v_add_f32 v27, v27, v81
    v_cvt_pk_bf16_f32 v56, v80, v81
    v_add_f32 v26, v26, v82
    v_add_f32 v27, v27, v83
    v_cvt_pk_bf16_f32 v57, v82, v83
    v_add_f32 v26, v26, v84
    v_add_f32 v27, v27, v85
    v_cvt_pk_bf16_f32 v58, v84, v85
    v_add_f32 v26, v26, v86
    v_add_f32 v27, v27, v87
    v_cvt_pk_bf16_f32 v59, v86, v87
    v_add_f32 v26, v26, v88
    v_add_f32 v27, v27, v89
    v_cvt_pk_bf16_f32 v60, v88, v89
    v_add_f32 v26, v26, v90
    v_add_f32 v27, v27, v91
    v_cvt_pk_bf16_f32 v61, v90, v91
    v_add_f32 v26, v26, v92
    v_add_f32 v27, v27, v93
    v_cvt_pk_bf16_f32 v62, v92, v93
    v_add_f32 v26, v26, v94
    v_add_f32 v27, v27, v95
    v_cvt_pk_bf16_f32 v63, v94, v95
    s_add_u32 m0, s65, 32768
    s_nop 0
    buffer_load_dwordx4 v6, s[28:31], s99 offen offset:0 nt lds
    ds_read_b128 v[96:99], v8 offset:8192
    ds_read_b128 v[100:103], v9 offset:8192
    ds_read_b128 v[104:107], v10 offset:8192
    ds_read_b128 v[108:111], v11 offset:8192
    ds_read_b128 v[112:115], v12 offset:8192
    ds_read_b128 v[116:119], v13 offset:8192
    buffer_load_dwordx4 v6, s[28:31], s99 offen offset:1024 nt lds
    ds_read_b128 v[120:123], v14 offset:8192
    ds_read_b128 v[124:127], v15 offset:8192
    v_max3_f32 v28, v64, v65, v66
    v_max3_f32 v28, v28, v67, v68
    v_max3_f32 v28, v28, v69, v70
    v_max3_f32 v28, v28, v71, v72
    v_max3_f32 v28, v28, v73, v74
    v_max3_f32 v28, v28, v75, v76
    v_max3_f32 v28, v28, v77, v78
    v_max_f32 v28, v28, v79
    v_cmp_lt_f32 vcc, s67, v28
    s_nop 1
    s_cbranch_vccnz L_rare1_40
L_back1_41:
    v_exp_f32 v64, v64
    v_exp_f32 v65, v65
    v_exp_f32 v66, v66
    v_exp_f32 v67, v67
    v_exp_f32 v68, v68
    v_exp_f32 v69, v69
    v_exp_f32 v70, v70
    v_exp_f32 v71, v71
    s_waitcnt lgkmcnt(0) vmcnt(4)
    s_barrier
    v_mfma_f32_32x32x16_bf16 v[80:95], v[96:99], v[160:163], v[32:47]
    s_add_u32 m0, s65, 49152
    s_nop 0
    buffer_load_dwordx4 v6, s[28:31], s100 offen offset:0 nt lds
    v_exp_f32 v72, v72
    v_exp_f32 v73, v73
    v_exp_f32 v74, v74
    v_exp_f32 v75, v75
    v_mfma_f32_32x32x16_bf16 v[80:95], v[100:103], v[164:167], v[80:95]
    v_exp_f32 v76, v76
    v_exp_f32 v77, v77
    v_exp_f32 v78, v78
    v_exp_f32 v79, v79
    v_mfma_f32_32x32x16_bf16 v[80:95], v[104:107], v[168:171], v[80:95]
    v_add_f32 v26, v26, v64
    v_add_f32 v27, v27, v65
    v_cvt_pk_bf16_f32 v48, v64, v65
    v_add_f32 v26, v26, v66
    v_mfma_f32_32x32x16_bf16 v[80:95], v[108:111], v[172:175], v[80:95]
    v_add_f32 v27, v27, v67
    v_cvt_pk_bf16_f32 v49, v66, v67
    v_add_f32 v26, v26, v68
    v_add_f32 v27, v27, v69
    v_mfma_f32_32x32x16_bf16 v[80:95], v[112:115], v[176:179], v[80:95]
    buffer_load_dwordx4 v6, s[28:31], s100 offen offset:1024 nt lds
    v_cvt_pk_bf16_f32 v50, v68, v69
    v_add_f32 v26, v26, v70
    v_add_f32 v27, v27, v71
    v_cvt_pk_bf16_f32 v51, v70, v71
    v_mfma_f32_32x32x16_bf16 v[80:95], v[116:119], v[180:183], v[80:95]
    v_add_f32 v26, v26, v72
    v_add_f32 v27, v27, v73
    v_cvt_pk_bf16_f32 v52, v72, v73
    v_add_f32 v26, v26, v74
    v_mfma_f32_32x32x16_bf16 v[80:95], v[120:123], v[184:187], v[80:95]
    v_add_f32 v27, v27, v75
    v_cvt_pk_bf16_f32 v53, v74, v75
    v_add_f32 v26, v26, v76
    v_add_f32 v27, v27, v77
    v_mfma_f32_32x32x16_bf16 v[80:95], v[124:127], v[188:191], v[80:95]
    v_cvt_pk_bf16_f32 v54, v76, v77
    v_add_f32 v26, v26, v78
    v_add_f32 v27, v27, v79
    v_cvt_pk_bf16_f32 v55, v78, v79
    s_add_u32 m0, s65, 57344
    s_nop 0
    buffer_load_dwordx4 v6, s[28:31], s101 offen offset:0 nt lds
    ds_read_b128 v[96:99], v8 offset:24576
    ds_read_b128 v[100:103], v9 offset:24576
    ds_read_b128 v[104:107], v10 offset:24576
    s_nop 1
    v_max3_f32 v28, v80, v81, v82
    v_max3_f32 v28, v28, v83, v84
    v_max3_f32 v28, v28, v85, v86
    ds_read_b128 v[108:111], v11 offset:24576
    v_max3_f32 v28, v28, v87, v88
    v_max3_f32 v28, v28, v89, v90
    v_max3_f32 v28, v28, v91, v92
    ds_read_b128 v[112:115], v12 offset:24576
    ds_read_b128 v[116:119], v13 offset:24576
    v_max3_f32 v28, v28, v93, v94
    v_max_f32 v28, v28, v95
    v_cmp_lt_f32 vcc, s67, v28
    buffer_load_dwordx4 v6, s[28:31], s101 offen offset:1024 nt lds
    ds_read_b128 v[120:123], v14 offset:24576
    s_cbranch_vccnz L_rare1_42
L_back1_43:
    v_exp_f32 v80, v80
    v_exp_f32 v81, v81
    ds_read_b128 v[124:127], v15 offset:24576
    v_exp_f32 v82, v82
    v_exp_f32 v83, v83
    v_exp_f32 v84, v84
    v_exp_f32 v85, v85
    v_exp_f32 v86, v86
    v_exp_f32 v87, v87
    s_waitcnt lgkmcnt(0) vmcnt(4)
    s_barrier
    v_mfma_f32_32x32x16_bf16 v[64:79], v[96:99], v[160:163], v[32:47]
    buffer_load_dword v31, v19, s[36:39], s83 offen
    v_exp_f32 v88, v88
    v_exp_f32 v89, v89
    v_exp_f32 v90, v90
    v_exp_f32 v91, v91
    v_mfma_f32_32x32x16_bf16 v[64:79], v[100:103], v[164:167], v[64:79]
    v_exp_f32 v92, v92
    v_exp_f32 v93, v93
    v_exp_f32 v94, v94
    v_exp_f32 v95, v95
    v_mfma_f32_32x32x16_bf16 v[64:79], v[104:107], v[168:171], v[64:79]
    v_add_f32 v26, v26, v80
    v_add_f32 v27, v27, v81
    v_cvt_pk_bf16_f32 v128, v80, v81
    v_add_f32 v26, v26, v82
    v_mfma_f32_32x32x16_bf16 v[64:79], v[108:111], v[172:175], v[64:79]
    v_add_f32 v27, v27, v83
    v_cvt_pk_bf16_f32 v129, v82, v83
    v_add_f32 v26, v26, v84
    v_add_f32 v27, v27, v85
    v_mfma_f32_32x32x16_bf16 v[64:79], v[112:115], v[176:179], v[64:79]
    v_cvt_pk_bf16_f32 v130, v84, v85
    v_add_f32 v26, v26, v86
    v_add_f32 v27, v27, v87
    v_cvt_pk_bf16_f32 v131, v86, v87
    v_mfma_f32_32x32x16_bf16 v[64:79], v[116:119], v[180:183], v[64:79]
    v_add_f32 v26, v26, v88
    v_add_f32 v27, v27, v89
    v_cvt_pk_bf16_f32 v132, v88, v89
    v_add_f32 v26, v26, v90
    v_mfma_f32_32x32x16_bf16 v[64:79], v[120:123], v[184:187], v[64:79]
    v_add_f32 v27, v27, v91
    v_cvt_pk_bf16_f32 v133, v90, v91
    v_add_f32 v26, v26, v92
    v_add_f32 v27, v27, v93
    v_mfma_f32_32x32x16_bf16 v[64:79], v[124:127], v[188:191], v[64:79]
    v_cvt_pk_bf16_f32 v134, v92, v93
    v_add_f32 v26, v26, v94
    v_add_f32 v27, v27, v95
    v_cvt_pk_bf16_f32 v135, v94, v95
    ds_read_b128 v[96:99], v8 offset:40960
    ds_read_b128 v[100:103], v9 offset:40960
    ds_read_b128 v[104:107], v10 offset:40960
    s_nop 4
    v_max3_f32 v28, v64, v65, v66
    v_max3_f32 v28, v28, v67, v68
    v_max3_f32 v28, v28, v69, v70
    ds_read_b128 v[108:111], v11 offset:40960
    v_max3_f32 v28, v28, v71, v72
    v_max3_f32 v28, v28, v73, v74
    v_max3_f32 v28, v28, v75, v76
    ds_read_b128 v[112:115], v12 offset:40960
    ds_read_b128 v[116:119], v13 offset:40960
    v_max3_f32 v28, v28, v77, v78
    v_max_f32 v28, v28, v79
    v_cmp_lt_f32 vcc, s67, v28
    ds_read_b128 v[120:123], v14 offset:40960
    s_nop 0
    s_cbranch_vccnz L_rare1_44
L_back1_45:
    v_exp_f32 v64, v64
    v_exp_f32 v65, v65
    ds_read_b128 v[124:127], v15 offset:40960
    v_exp_f32 v66, v66
    v_exp_f32 v67, v67
    v_exp_f32 v68, v68
    v_exp_f32 v69, v69
    v_exp_f32 v70, v70
    v_exp_f32 v71, v71
    s_waitcnt lgkmcnt(0) vmcnt(1)
    s_barrier
    v_mfma_f32_32x32x16_bf16 v[80:95], v[96:99], v[160:163], v[32:47]
    v_exp_f32 v72, v72
    v_exp_f32 v73, v73
    v_exp_f32 v74, v74
    v_exp_f32 v75, v75
    v_lshrrev_b32 v13, 4, v1
    v_and_b32 v14, 15, v1
    v_xor_b32 v8, s71, v14
    v_lshlrev_b32 v8, 4, v8
    v_lshl_add_u32 v8, v13, 14, v8
    v_mfma_f32_32x32x16_bf16 v[80:95], v[100:103], v[164:167], v[80:95]
    v_exp_f32 v76, v76
    v_exp_f32 v77, v77
    v_exp_f32 v78, v78
    v_exp_f32 v79, v79
    v_mfma_f32_32x32x16_bf16 v[80:95], v[104:107], v[168:171], v[80:95]
    v_add_f32 v26, v26, v64
    v_add_f32 v27, v27, v65
    v_cvt_pk_bf16_f32 v136, v64, v65
    v_add_f32 v26, v26, v66
    v_mfma_f32_32x32x16_bf16 v[80:95], v[108:111], v[172:175], v[80:95]
    v_add_f32 v27, v27, v67
    v_cvt_pk_bf16_f32 v137, v66, v67
    v_add_f32 v26, v26, v68
    v_add_f32 v27, v27, v69
    v_mfma_f32_32x32x16_bf16 v[80:95], v[112:115], v[176:179], v[80:95]
    v_cvt_pk_bf16_f32 v138, v68, v69
    v_add_f32 v26, v26, v70
    v_add_f32 v27, v27, v71
    v_cvt_pk_bf16_f32 v139, v70, v71
    v_mfma_f32_32x32x16_bf16 v[80:95], v[116:119], v[180:183], v[80:95]
    v_add_f32 v26, v26, v72
    v_add_f32 v27, v27, v73
    v_cvt_pk_bf16_f32 v140, v72, v73
    v_add_f32 v26, v26, v74
    v_mfma_f32_32x32x16_bf16 v[80:95], v[120:123], v[184:187], v[80:95]
    v_add_f32 v27, v27, v75
    v_cvt_pk_bf16_f32 v141, v74, v75
    v_add_f32 v26, v26, v76
    v_add_f32 v27, v27, v77
    v_mfma_f32_32x32x16_bf16 v[80:95], v[124:127], v[188:191], v[80:95]
    v_cvt_pk_bf16_f32 v142, v76, v77
    v_add_f32 v26, v26, v78
    v_add_f32 v27, v27, v79
    v_cvt_pk_bf16_f32 v143, v78, v79
    ds_read_b64_tr_b16 v[104:105], v22 offset:0
    ds_read_b64_tr_b16 v[106:107], v22 offset:2048
    ds_read_b64_tr_b16 v[108:109], v23 offset:0
    s_lshl_b32 s75, s84, 16
    s_add_u32 s75, s75, s82
    buffer_load_dwordx4 v[160:163], v8, s[36:39], s75 offen offset:0
    ds_read_b64_tr_b16 v[110:111], v23 offset:2048
    ds_read_b64_tr_b16 v[96:97], v20 offset:0
    ds_read_b64_tr_b16 v[98:99], v20 offset:2048
    v_max3_f32 v28, v80, v81, v82
    v_max3_f32 v28, v28, v83, v84
    v_max3_f32 v28, v28, v85, v86
    v_max3_f32 v28, v28, v87, v88
    v_max3_f32 v28, v28, v89, v90
    buffer_load_dwordx4 v[164:167], v8, s[36:39], s75 offen offset:2048
    ds_read_b64_tr_b16 v[100:101], v21 offset:0
    ds_read_b64_tr_b16 v[102:103], v21 offset:2048
    v_max3_f32 v28, v28, v91, v92
    v_max3_f32 v28, v28, v93, v94
    v_max_f32 v28, v28, v95
    v_cmp_lt_f32 vcc, s67, v28
    s_add_u32 s75, s75, 4096
    buffer_load_dwordx4 v[168:171], v8, s[36:39], s75 offen offset:0
    ds_read_b64_tr_b16 v[120:121], v22 offset:4096
    ds_read_b64_tr_b16 v[122:123], v22 offset:6144
    ds_read_b64_tr_b16 v[124:125], v23 offset:4096
    s_cbranch_vccnz L_rare1_46
L_back1_47:
    v_exp_f32 v80, v80
    v_exp_f32 v81, v81
    v_exp_f32 v82, v82
    buffer_load_dwordx4 v[172:175], v8, s[36:39], s75 offen offset:2048
    ds_read_b64_tr_b16 v[126:127], v23 offset:6144
    ds_read_b64_tr_b16 v[112:113], v20 offset:4096
    ds_read_b64_tr_b16 v[114:115], v20 offset:6144
    v_exp_f32 v83, v83
    v_exp_f32 v84, v84
    v_exp_f32 v85, v85
    v_exp_f32 v86, v86
    v_exp_f32 v87, v87
    s_add_u32 s75, s75, 4096
    buffer_load_dwordx4 v[176:179], v8, s[36:39], s75 offen offset:0
    ds_read_b64_tr_b16 v[116:117], v21 offset:4096
    ds_read_b64_tr_b16 v[118:119], v21 offset:6144
    v_exp_f32 v88, v88
    v_exp_f32 v89, v89
    v_exp_f32 v90, v90
    v_exp_f32 v91, v91
    buffer_load_dwordx4 v[180:183], v8, s[36:39], s75 offen offset:2048
    v_exp_f32 v92, v92
    v_exp_f32 v93, v93
    v_exp_f32 v94, v94
    v_exp_f32 v95, v95
    v_add_f32 v26, v26, v80
    v_add_f32 v27, v27, v81
    v_cvt_pk_bf16_f32 v144, v80, v81
    v_add_f32 v26, v26, v82
    v_add_f32 v27, v27, v83
    v_cvt_pk_bf16_f32 v145, v82, v83
    v_add_f32 v26, v26, v84
    v_add_f32 v27, v27, v85
    v_cvt_pk_bf16_f32 v146, v84, v85
    v_add_f32 v26, v26, v86
    v_add_f32 v27, v27, v87
    v_cvt_pk_bf16_f32 v147, v86, v87
    v_add_f32 v26, v26, v88
    v_add_f32 v27, v27, v89
    v_cvt_pk_bf16_f32 v148, v88, v89
    v_add_f32 v26, v26, v90
    v_add_f32 v27, v27, v91
    v_cvt_pk_bf16_f32 v149, v90, v91
    v_add_f32 v26, v26, v92
    v_add_f32 v27, v27, v93
    v_cvt_pk_bf16_f32 v150, v92, v93
    v_add_f32 v26, v26, v94
    v_add_f32 v27, v27, v95
    v_cvt_pk_bf16_f32 v151, v94, v95
    s_barrier
    v_add_f32 v25, v27, v26
    v_mov_b32 v29, v25
    v_lshlrev_b32 v15, 4, v1
    s_sub_u32 s72, s91, s58
    s_sub_u32 s72, s72, 1
    v_permlane32_swap_b32 v29, v25
    s_and_b32 s72, s72, 3
    s_lshl_b32 s73, s72, 1
    s_add_u32 s73, s73, 1
    s_cmp_eq_u32 s72, 3
    s_cselect_b32 s72, 8, s73
    s_lshl_b32 s72, s72, 13
    s_mul_i32 s73, s64, 81920
    s_sub_u32 s76, 81920, s73
    v_add_f32 v25, v25, v29
    s_add_u32 s74, s72, s73
    v_add_u32 v45, s74, v15
    s_add_u32 s74, s72, s76
    v_add_u32 v40, s74, v15
    v_lshlrev_b32 v46, 3, v1
    s_lshl_b32 s72, s91, 9
    s_add_u32 s72, s72, 73728
    s_add_u32 s74, s72, s73
    v_add_u32 v47, s74, v46
    s_add_u32 s74, s72, s76
    v_add_u32 v41, s74, v46
    ds_write_b64 v47, v[24:25]
    s_lshl_b32 s73, s3, 13
    s_add_u32 s73, s73, 4194304
    s_lshl_b32 s76, s64, 12
    s_add_u32 s73, s73, s76
    s_lshl_b32 s72, s3, 8
    s_add_u32 s72, s72, 131072
    s_lshr_b32 s74, s3, 4
    s_lshl_b32 s74, s74, 2
    s_add_u32 s74, s74, s58
    s_lshl_b32 s74, s74, 10
    s_add_u32 s74, s74, 655360
    s_lshl_b32 s76, s91, 1
    s_add_u32 s76, s76, s64
    s_lshl_b32 s76, s76, 7
    s_add_u32 s74, s74, s76
    v_lshlrev_b32 v44, 4, v14
    v_bfe_u32 v42, v1, 4, 1
    v_lshl_add_u32 v44, v42, 10, v44
    v_lshrrev_b32 v42, 5, v1
    v_lshl_add_u32 v44, v42, 8, v44
    s_barrier
    s_waitcnt lgkmcnt(0)
    v_mfma_f32_32x32x16_bf16 v[224:239], v[104:107], v[56:59], v[224:239]
    ds_read_b64_tr_b16 v[72:73], v22 offset:16384
    ds_read_b64_tr_b16 v[74:75], v22 offset:18432
    ds_read_b64_tr_b16 v[76:77], v23 offset:16384
    ds_read_b64_tr_b16 v[78:79], v23 offset:18432
    v_mfma_f32_32x32x16_bf16 v[240:255], v[108:111], v[56:59], v[240:255]
    ds_read_b64_tr_b16 v[64:65], v20 offset:16384
    ds_read_b64_tr_b16 v[66:67], v20 offset:18432
    ds_read_b64_tr_b16 v[68:69], v21 offset:16384
    ds_read_b64_tr_b16 v[70:71], v21 offset:18432
    v_mfma_f32_32x32x16_bf16 v[192:207], v[96:99], v[56:59], v[192:207]
    ds_read_b64_tr_b16 v[88:89], v22 offset:20480
    ds_read_b64_tr_b16 v[90:91], v22 offset:22528
    ds_read_b64_tr_b16 v[92:93], v23 offset:20480
    ds_read_b64_tr_b16 v[94:95], v23 offset:22528
    v_mfma_f32_32x32x16_bf16 v[208:223], v[100:103], v[56:59], v[208:223]
    ds_read_b64_tr_b16 v[80:81], v20 offset:20480
    ds_read_b64_tr_b16 v[82:83], v20 offset:22528
    ds_read_b64_tr_b16 v[84:85], v21 offset:20480
    ds_read_b64_tr_b16 v[86:87], v21 offset:22528
    v_mfma_f32_32x32x16_bf16 v[224:239], v[120:123], v[60:63], v[224:239]
    v_mfma_f32_32x32x16_bf16 v[240:255], v[124:127], v[60:63], v[240:255]
    v_mfma_f32_32x32x16_bf16 v[192:207], v[112:115], v[60:63], v[192:207]
    v_mfma_f32_32x32x16_bf16 v[208:223], v[116:119], v[60:63], v[208:223]
    s_waitcnt lgkmcnt(0)
    v_mfma_f32_32x32x16_bf16 v[224:239], v[72:75], v[48:51], v[224:239]
    ds_read_b64_tr_b16 v[104:105], v22 offset:32768
    ds_read_b64_tr_b16 v[106:107], v22 offset:34816
    ds_read_b64_tr_b16 v[108:109], v23 offset:32768
    ds_read_b64_tr_b16 v[110:111], v23 offset:34816
    v_mfma_f32_32x32x16_bf16 v[240:255], v[76:79], v[48:51], v[240:255]
    ds_read_b64_tr_b16 v[96:97], v20 offset:32768
    ds_read_b64_tr_b16 v[98:99], v20 offset:34816
    ds_read_b64_tr_b16 v[100:101], v21 offset:32768
    ds_read_b64_tr_b16 v[102:103], v21 offset:34816
    v_mfma_f32_32x32x16_bf16 v[192:207], v[64:67], v[48:51], v[192:207]
    ds_read_b64_tr_b16 v[120:121], v22 offset:36864
    ds_read_b64_tr_b16 v[122:123], v22 offset:38912
    ds_read_b64_tr_b16 v[124:125], v23 offset:36864
    ds_read_b64_tr_b16 v[126:127], v23 offset:38912
    v_mfma_f32_32x32x16_bf16 v[208:223], v[68:71], v[48:51], v[208:223]
    ds_read_b64_tr_b16 v[112:113], v20 offset:36864
    ds_read_b64_tr_b16 v[114:115], v20 offset:38912
    ds_read_b64_tr_b16 v[116:117], v21 offset:36864
    ds_read_b64_tr_b16 v[118:119], v21 offset:38912
    v_mfma_f32_32x32x16_bf16 v[224:239], v[88:91], v[52:55], v[224:239]
    v_mfma_f32_32x32x16_bf16 v[240:255], v[92:95], v[52:55], v[240:255]
    v_mfma_f32_32x32x16_bf16 v[192:207], v[80:83], v[52:55], v[192:207]
    v_mfma_f32_32x32x16_bf16 v[208:223], v[84:87], v[52:55], v[208:223]
    s_waitcnt lgkmcnt(0)
    v_mfma_f32_32x32x16_bf16 v[224:239], v[104:107], v[128:131], v[224:239]
    ds_read_b64_tr_b16 v[72:73], v22 offset:49152
    ds_read_b64_tr_b16 v[74:75], v22 offset:51200
    ds_read_b64_tr_b16 v[76:77], v23 offset:49152
    ds_read_b64_tr_b16 v[78:79], v23 offset:51200
    v_mfma_f32_32x32x16_bf16 v[240:255], v[108:111], v[128:131], v[240:255]
    ds_read_b64_tr_b16 v[64:65], v20 offset:49152
    ds_read_b64_tr_b16 v[66:67], v20 offset:51200
    ds_read_b64_tr_b16 v[68:69], v21 offset:49152
    ds_read_b64_tr_b16 v[70:71], v21 offset:51200
    v_mfma_f32_32x32x16_bf16 v[192:207], v[96:99], v[128:131], v[192:207]
    ds_read_b64_tr_b16 v[88:89], v22 offset:53248
    ds_read_b64_tr_b16 v[90:91], v22 offset:55296
    ds_read_b64_tr_b16 v[92:93], v23 offset:53248
    ds_read_b64_tr_b16 v[94:95], v23 offset:55296
    v_mfma_f32_32x32x16_bf16 v[208:223], v[100:103], v[128:131], v[208:223]
    ds_read_b64_tr_b16 v[80:81], v20 offset:53248
    ds_read_b64_tr_b16 v[82:83], v20 offset:55296
    ds_read_b64_tr_b16 v[84:85], v21 offset:53248
    ds_read_b64_tr_b16 v[86:87], v21 offset:55296
    v_mfma_f32_32x32x16_bf16 v[224:239], v[120:123], v[132:135], v[224:239]
    v_mfma_f32_32x32x16_bf16 v[240:255], v[124:127], v[132:135], v[240:255]
    v_mfma_f32_32x32x16_bf16 v[192:207], v[112:115], v[132:135], v[192:207]
    v_mfma_f32_32x32x16_bf16 v[208:223], v[116:119], v[132:135], v[208:223]
    s_waitcnt lgkmcnt(0)
    v_mfma_f32_32x32x16_bf16 v[224:239], v[72:75], v[136:139], v[224:239]
    ds_read_b64_tr_b16 v[104:105], v22 offset:57344
    ds_read_b64_tr_b16 v[106:107], v22 offset:59392
    ds_read_b64_tr_b16 v[108:109], v23 offset:57344
    ds_read_b64_tr_b16 v[110:111], v23 offset:59392
    v_mfma_f32_32x32x16_bf16 v[240:255], v[76:79], v[136:139], v[240:255]
    ds_read_b64_tr_b16 v[96:97], v20 offset:57344
    ds_read_b64_tr_b16 v[98:99], v20 offset:59392
    ds_read_b64_tr_b16 v[100:101], v21 offset:57344
    ds_read_b64_tr_b16 v[102:103], v21 offset:59392
    v_mfma_f32_32x32x16_bf16 v[192:207], v[64:67], v[136:139], v[192:207]
    ds_read_b64_tr_b16 v[120:121], v22 offset:61440
    ds_read_b64_tr_b16 v[122:123], v22 offset:63488
    ds_read_b64_tr_b16 v[124:125], v23 offset:61440
    ds_read_b64_tr_b16 v[126:127], v23 offset:63488
    v_mfma_f32_32x32x16_bf16 v[208:223], v[68:71], v[136:139], v[208:223]
    ds_read_b64_tr_b16 v[112:113], v20 offset:61440
    ds_read_b64_tr_b16 v[114:115], v20 offset:63488
    ds_read_b64_tr_b16 v[116:117], v21 offset:61440
    ds_read_b64_tr_b16 v[118:119], v21 offset:63488
    v_mfma_f32_32x32x16_bf16 v[224:239], v[88:91], v[140:143], v[224:239]
    v_mfma_f32_32x32x16_bf16 v[240:255], v[92:95], v[140:143], v[240:255]
    v_mfma_f32_32x32x16_bf16 v[192:207], v[80:83], v[140:143], v[192:207]
    v_mfma_f32_32x32x16_bf16 v[208:223], v[84:87], v[140:143], v[208:223]
    s_waitcnt lgkmcnt(0)
    v_mfma_f32_32x32x16_bf16 v[224:239], v[104:107], v[144:147], v[224:239]
    v_mfma_f32_32x32x16_bf16 v[240:255], v[108:111], v[144:147], v[240:255]
    v_mfma_f32_32x32x16_bf16 v[192:207], v[96:99], v[144:147], v[192:207]
    v_mfma_f32_32x32x16_bf16 v[208:223], v[100:103], v[144:147], v[208:223]
    v_mfma_f32_32x32x16_bf16 v[224:239], v[120:123], v[148:151], v[224:239]
    v_mfma_f32_32x32x16_bf16 v[240:255], v[124:127], v[148:151], v[240:255]
    v_mfma_f32_32x32x16_bf16 v[192:207], v[112:115], v[148:151], v[192:207]
    v_mfma_f32_32x32x16_bf16 v[208:223], v[116:119], v[148:151], v[208:223]
    s_nop 8
    ds_write_b128 v45, v[224:227] offset:0
    ds_write_b128 v45, v[228:231] offset:1024
    ds_write_b128 v45, v[232:235] offset:2048
    ds_write_b128 v45, v[236:239] offset:3072
    ds_write_b128 v45, v[240:243] offset:4096
    ds_write_b128 v45, v[244:247] offset:5120
    ds_write_b128 v45, v[248:251] offset:6144
    ds_write_b128 v45, v[252:255] offset:7168
    s_lshl_b32 s75, s84, 16
    s_add_u32 s75, s75, s82
    s_add_u32 s75, s75, 12288
    buffer_load_dwordx4 v[184:187], v8, s[36:39], s75 offen offset:0
    buffer_load_dwordx4 v[188:191], v8, s[36:39], s75 offen offset:2048
    s_lshl_b32 s75, s85, 16
    s_add_u32 s75, s75, s82
    buffer_load_dwordx4 v[128:131], v8, s[36:39], s75 offen offset:0
    buffer_load_dwordx4 v[132:135], v8, s[36:39], s75 offen offset:2048
    s_add_u32 s75, s75, 4096
    buffer_load_dwordx4 v[136:139], v8, s[36:39], s75 offen offset:0
    buffer_load_dwordx4 v[140:143], v8, s[36:39], s75 offen offset:2048
    s_waitcnt lgkmcnt(0)
    s_barrier
    ds_read_b64 v[34:35], v41
    ds_read_b128 v[224:227], v40 offset:0
    ds_read_b128 v[228:231], v40 offset:1024
    ds_read_b128 v[232:235], v40 offset:2048
    ds_read_b128 v[236:239], v40 offset:3072
    ds_read_b128 v[240:243], v40 offset:4096
    ds_read_b128 v[244:247], v40 offset:5120
    ds_read_b128 v[248:251], v40 offset:6144
    ds_read_b128 v[252:255], v40 offset:7168
    s_waitcnt lgkmcnt(8)
    v_max_f32 v32, v24, v34
    v_sub_f32 v40, v24, v32
    v_sub_f32 v41, v34, v32
    v_exp_f32 v40, v40
    v_exp_f32 v41, v41
    s_nop 0
    v_pk_mul_f32 v[192:193], v[192:193], v[40:41] op_sel:[0,0] op_sel_hi:[1,0]
    v_pk_mul_f32 v[194:195], v[194:195], v[40:41] op_sel:[0,0] op_sel_hi:[1,0]
    v_pk_mul_f32 v[196:197], v[196:197], v[40:41] op_sel:[0,0] op_sel_hi:[1,0]
    v_pk_mul_f32 v[198:199], v[198:199], v[40:41] op_sel:[0,0] op_sel_hi:[1,0]
    v_pk_mul_f32 v[200:201], v[200:201], v[40:41] op_sel:[0,0] op_sel_hi:[1,0]
    v_pk_mul_f32 v[202:203], v[202:203], v[40:41] op_sel:[0,0] op_sel_hi:[1,0]
    v_pk_mul_f32 v[204:205], v[204:205], v[40:41] op_sel:[0,0] op_sel_hi:[1,0]
    v_pk_mul_f32 v[206:207], v[206:207], v[40:41] op_sel:[0,0] op_sel_hi:[1,0]
    v_pk_mul_f32 v[208:209], v[208:209], v[40:41] op_sel:[0,0] op_sel_hi:[1,0]
    v_pk_mul_f32 v[210:211], v[210:211], v[40:41] op_sel:[0,0] op_sel_hi:[1,0]
    v_pk_mul_f32 v[212:213], v[212:213], v[40:41] op_sel:[0,0] op_sel_hi:[1,0]
    v_pk_mul_f32 v[214:215], v[214:215], v[40:41] op_sel:[0,0] op_sel_hi:[1,0]
    v_pk_mul_f32 v[216:217], v[216:217], v[40:41] op_sel:[0,0] op_sel_hi:[1,0]
    v_pk_mul_f32 v[218:219], v[218:219], v[40:41] op_sel:[0,0] op_sel_hi:[1,0]
    v_pk_mul_f32 v[220:221], v[220:221], v[40:41] op_sel:[0,0] op_sel_hi:[1,0]
    v_pk_mul_f32 v[222:223], v[222:223], v[40:41] op_sel:[0,0] op_sel_hi:[1,0]
    v_mul_f32 v33, v25, v40
    v_fmac_f32 v33, v35, v41
    s_waitcnt lgkmcnt(0)
    v_pk_fma_f32 v[192:193], v[224:225], v[40:41], v[192:193] op_sel:[0,1,0] op_sel_hi:[1,1,1]
    v_pk_fma_f32 v[194:195], v[226:227], v[40:41], v[194:195] op_sel:[0,1,0] op_sel_hi:[1,1,1]
    v_pk_fma_f32 v[196:197], v[228:229], v[40:41], v[196:197] op_sel:[0,1,0] op_sel_hi:[1,1,1]
    v_pk_fma_f32 v[198:199], v[230:231], v[40:41], v[198:199] op_sel:[0,1,0] op_sel_hi:[1,1,1]
    v_pk_fma_f32 v[200:201], v[232:233], v[40:41], v[200:201] op_sel:[0,1,0] op_sel_hi:[1,1,1]
    v_pk_fma_f32 v[202:203], v[234:235], v[40:41], v[202:203] op_sel:[0,1,0] op_sel_hi:[1,1,1]
    v_pk_fma_f32 v[204:205], v[236:237], v[40:41], v[204:205] op_sel:[0,1,0] op_sel_hi:[1,1,1]
    v_pk_fma_f32 v[206:207], v[238:239], v[40:41], v[206:207] op_sel:[0,1,0] op_sel_hi:[1,1,1]
    v_pk_fma_f32 v[208:209], v[240:241], v[40:41], v[208:209] op_sel:[0,1,0] op_sel_hi:[1,1,1]
    v_pk_fma_f32 v[210:211], v[242:243], v[40:41], v[210:211] op_sel:[0,1,0] op_sel_hi:[1,1,1]
    v_pk_fma_f32 v[212:213], v[244:245], v[40:41], v[212:213] op_sel:[0,1,0] op_sel_hi:[1,1,1]
    v_pk_fma_f32 v[214:215], v[246:247], v[40:41], v[214:215] op_sel:[0,1,0] op_sel_hi:[1,1,1]
    v_pk_fma_f32 v[216:217], v[248:249], v[40:41], v[216:217] op_sel:[0,1,0] op_sel_hi:[1,1,1]
    v_pk_fma_f32 v[218:219], v[250:251], v[40:41], v[218:219] op_sel:[0,1,0] op_sel_hi:[1,1,1]
    v_pk_fma_f32 v[220:221], v[252:253], v[40:41], v[220:221] op_sel:[0,1,0] op_sel_hi:[1,1,1]
    v_pk_fma_f32 v[222:223], v[254:255], v[40:41], v[222:223] op_sel:[0,1,0] op_sel_hi:[1,1,1]
    s_and_b32 s74, s74, -256
    v_and_b32 v46, 0xff, v46
    s_xor_b32 s78, s74, 1024
    s_xor_b32 s94, s73, 8192
    s_xor_b32 s98, s72, 256
    s_xor_b32 s79, s74, 2048
    s_xor_b32 s95, s73, 16384
    s_xor_b32 s99, s72, 512
    s_xor_b32 s80, s74, 3072
    s_xor_b32 s96, s73, 24576
    s_xor_b32 s100, s72, 768
    s_mov_b32 s77, 0
L_poll_48:
    s_load_dwordx2 s[4:5], s[18:19], s78 offset:0 glc
    s_load_dwordx2 s[6:7], s[18:19], s78 offset:128 glc
    s_load_dwordx2 s[8:9], s[18:19], s79 offset:0 glc
    s_load_dwordx2 s[10:11], s[18:19], s79 offset:128 glc
    s_load_dwordx2 s[12:13], s[18:19], s80 offset:0 glc
    s_load_dwordx2 s[14:15], s[18:19], s80 offset:128 glc
    s_waitcnt lgkmcnt(0)
    s_mov_b32 s76, 1
    s_cmp_eq_u64 s[4:5], s[62:63]
    s_cselect_b32 s76, s76, 0
    s_cmp_eq_u64 s[6:7], s[62:63]
    s_cselect_b32 s76, s76, 0
    s_cmp_eq_u64 s[8:9], s[62:63]
    s_cselect_b32 s76, s76, 0
    s_cmp_eq_u64 s[10:11], s[62:63]
    s_cselect_b32 s76, s76, 0
    s_cmp_eq_u64 s[12:13], s[62:63]
    s_cselect_b32 s76, s76, 0
    s_cmp_eq_u64 s[14:15], s[62:63]
    s_cselect_b32 s76, s76, 0
    s_cmp_lg_u32 s76, 0
    s_cbranch_scc1 L_polld_49
    s_add_u32 s77, s77, 1
    s_cmp_lt_u32 s77, 40000
    s_cbranch_scc1 L_poll_48
L_polld_49:
    buffer_load_dwordx2 v[34:35], v46, s[48:51], s98 offen sc1
    buffer_load_dwordx2 v[36:37], v46, s[48:51], s99 offen sc1
    buffer_load_dwordx2 v[38:39], v46, s[48:51], s100 offen sc1
    buffer_load_dwordx4 v[224:227], v15, s[48:51], s94 offen offset:0 sc1
    buffer_load_dwordx4 v[228:231], v15, s[48:51], s94 offen offset:1024 sc1
    buffer_load_dwordx4 v[232:235], v15, s[48:51], s94 offen offset:2048 sc1
    buffer_load_dwordx4 v[236:239], v15, s[48:51], s94 offen offset:3072 sc1
    buffer_load_dwordx4 v[240:243], v15, s[48:51], s95 offen offset:0 sc1
    buffer_load_dwordx4 v[244:247], v15, s[48:51], s95 offen offset:1024 sc1
    buffer_load_dwordx4 v[248:251], v15, s[48:51], s95 offen offset:2048 sc1
    buffer_load_dwordx4 v[252:255], v15, s[48:51], s95 offen offset:3072 sc1
    buffer_load_dwordx4 v[64:67], v15, s[48:51], s96 offen offset:0 sc1
    buffer_load_dwordx4 v[68:71], v15, s[48:51], s96 offen offset:1024 sc1
    buffer_load_dwordx4 v[72:75], v15, s[48:51], s96 offen offset:2048 sc1
    buffer_load_dwordx4 v[76:79], v15, s[48:51], s96 offen offset:3072 sc1
    s_lshr_b32 s72, s3, 2
    s_lshl_b32 s73, s72, 13
    s_add_u32 s73, s73, 17825792
    s_lshl_b32 s75, s64, 12
    s_add_u32 s73, s73, s75
    s_lshl_b32 s74, s72, 8
    s_add_u32 s74, s74, 0xe0000
    s_lshl_b32 s75, s64, 7
    s_add_u32 s74, s74, s75
    s_waitcnt vmcnt(12)
    v_max3_f32 v28, v32, v34, v36
    v_max_f32 v28, v28, v38
    v_sub_f32 v40, v32, v28
    v_sub_f32 v41, v34, v28
    v_sub_f32 v42, v36, v28
    v_sub_f32 v43, v38, v28
    v_exp_f32 v40, v40
    v_exp_f32 v41, v41
    v_exp_f32 v42, v42
    v_exp_f32 v43, v43
    v_mul_f32 v28, v33, v40
    v_fmac_f32 v28, v35, v41
    v_fmac_f32 v28, v37, v42
    v_fmac_f32 v28, v39, v43
    v_rcp_f32 v28, v28
    s_nop 0
    v_mul_f32 v40, v40, v28
    v_mul_f32 v41, v41, v28
    v_mul_f32 v42, v42, v28
    v_mul_f32 v43, v43, v28
    v_pk_mul_f32 v[192:193], v[192:193], v[40:41] op_sel:[0,0] op_sel_hi:[1,0]
    v_pk_mul_f32 v[194:195], v[194:195], v[40:41] op_sel:[0,0] op_sel_hi:[1,0]
    v_pk_mul_f32 v[196:197], v[196:197], v[40:41] op_sel:[0,0] op_sel_hi:[1,0]
    v_pk_mul_f32 v[198:199], v[198:199], v[40:41] op_sel:[0,0] op_sel_hi:[1,0]
    v_pk_mul_f32 v[200:201], v[200:201], v[40:41] op_sel:[0,0] op_sel_hi:[1,0]
    v_pk_mul_f32 v[202:203], v[202:203], v[40:41] op_sel:[0,0] op_sel_hi:[1,0]
    v_pk_mul_f32 v[204:205], v[204:205], v[40:41] op_sel:[0,0] op_sel_hi:[1,0]
    v_pk_mul_f32 v[206:207], v[206:207], v[40:41] op_sel:[0,0] op_sel_hi:[1,0]
    v_pk_mul_f32 v[208:209], v[208:209], v[40:41] op_sel:[0,0] op_sel_hi:[1,0]
    v_pk_mul_f32 v[210:211], v[210:211], v[40:41] op_sel:[0,0] op_sel_hi:[1,0]
    v_pk_mul_f32 v[212:213], v[212:213], v[40:41] op_sel:[0,0] op_sel_hi:[1,0]
    v_pk_mul_f32 v[214:215], v[214:215], v[40:41] op_sel:[0,0] op_sel_hi:[1,0]
    v_pk_mul_f32 v[216:217], v[216:217], v[40:41] op_sel:[0,0] op_sel_hi:[1,0]
    v_pk_mul_f32 v[218:219], v[218:219], v[40:41] op_sel:[0,0] op_sel_hi:[1,0]
    v_pk_mul_f32 v[220:221], v[220:221], v[40:41] op_sel:[0,0] op_sel_hi:[1,0]
    v_pk_mul_f32 v[222:223], v[222:223], v[40:41] op_sel:[0,0] op_sel_hi:[1,0]
    s_waitcnt vmcnt(8)
    v_lshlrev_b32 v48, 16, v224
    v_and_b32 v49, 0xffff0000, v224
    v_pk_fma_f32 v[192:193], v[48:49], v[40:41], v[192:193] op_sel:[0,1,0] op_sel_hi:[1,1,1]
    v_lshlrev_b32 v50, 16, v225
    v_and_b32 v51, 0xffff0000, v225
    v_pk_fma_f32 v[194:195], v[50:51], v[40:41], v[194:195] op_sel:[0,1,0] op_sel_hi:[1,1,1]
    v_lshlrev_b32 v48, 16, v226
    v_and_b32 v49, 0xffff0000, v226
    v_pk_fma_f32 v[196:197], v[48:49], v[40:41], v[196:197] op_sel:[0,1,0] op_sel_hi:[1,1,1]
    v_lshlrev_b32 v50, 16, v227
    v_and_b32 v51, 0xffff0000, v227
    v_pk_fma_f32 v[198:199], v[50:51], v[40:41], v[198:199] op_sel:[0,1,0] op_sel_hi:[1,1,1]
    v_lshlrev_b32 v48, 16, v228
    v_and_b32 v49, 0xffff0000, v228
    v_pk_fma_f32 v[200:201], v[48:49], v[40:41], v[200:201] op_sel:[0,1,0] op_sel_hi:[1,1,1]
    v_lshlrev_b32 v50, 16, v229
    v_and_b32 v51, 0xffff0000, v229
    v_pk_fma_f32 v[202:203], v[50:51], v[40:41], v[202:203] op_sel:[0,1,0] op_sel_hi:[1,1,1]
    v_lshlrev_b32 v48, 16, v230
    v_and_b32 v49, 0xffff0000, v230
    v_pk_fma_f32 v[204:205], v[48:49], v[40:41], v[204:205] op_sel:[0,1,0] op_sel_hi:[1,1,1]
    v_lshlrev_b32 v50, 16, v231
    v_and_b32 v51, 0xffff0000, v231
    v_pk_fma_f32 v[206:207], v[50:51], v[40:41], v[206:207] op_sel:[0,1,0] op_sel_hi:[1,1,1]
    v_lshlrev_b32 v48, 16, v232
    v_and_b32 v49, 0xffff0000, v232
    v_pk_fma_f32 v[208:209], v[48:49], v[40:41], v[208:209] op_sel:[0,1,0] op_sel_hi:[1,1,1]
    v_lshlrev_b32 v50, 16, v233
    v_and_b32 v51, 0xffff0000, v233
    v_pk_fma_f32 v[210:211], v[50:51], v[40:41], v[210:211] op_sel:[0,1,0] op_sel_hi:[1,1,1]
    v_lshlrev_b32 v48, 16, v234
    v_and_b32 v49, 0xffff0000, v234
    v_pk_fma_f32 v[212:213], v[48:49], v[40:41], v[212:213] op_sel:[0,1,0] op_sel_hi:[1,1,1]
    v_lshlrev_b32 v50, 16, v235
    v_and_b32 v51, 0xffff0000, v235
    v_pk_fma_f32 v[214:215], v[50:51], v[40:41], v[214:215] op_sel:[0,1,0] op_sel_hi:[1,1,1]
    v_lshlrev_b32 v48, 16, v236
    v_and_b32 v49, 0xffff0000, v236
    v_pk_fma_f32 v[216:217], v[48:49], v[40:41], v[216:217] op_sel:[0,1,0] op_sel_hi:[1,1,1]
    v_lshlrev_b32 v50, 16, v237
    v_and_b32 v51, 0xffff0000, v237
    v_pk_fma_f32 v[218:219], v[50:51], v[40:41], v[218:219] op_sel:[0,1,0] op_sel_hi:[1,1,1]
    v_lshlrev_b32 v48, 16, v238
    v_and_b32 v49, 0xffff0000, v238
    v_pk_fma_f32 v[220:221], v[48:49], v[40:41], v[220:221] op_sel:[0,1,0] op_sel_hi:[1,1,1]
    v_lshlrev_b32 v50, 16, v239
    v_and_b32 v51, 0xffff0000, v239
    v_pk_fma_f32 v[222:223], v[50:51], v[40:41], v[222:223] op_sel:[0,1,0] op_sel_hi:[1,1,1]
    s_waitcnt vmcnt(4)
    v_lshlrev_b32 v48, 16, v240
    v_and_b32 v49, 0xffff0000, v240
    v_pk_fma_f32 v[192:193], v[48:49], v[42:43], v[192:193] op_sel:[0,0,0] op_sel_hi:[1,0,1]
    v_lshlrev_b32 v50, 16, v241
    v_and_b32 v51, 0xffff0000, v241
    v_pk_fma_f32 v[194:195], v[50:51], v[42:43], v[194:195] op_sel:[0,0,0] op_sel_hi:[1,0,1]
    v_lshlrev_b32 v48, 16, v242
    v_and_b32 v49, 0xffff0000, v242
    v_pk_fma_f32 v[196:197], v[48:49], v[42:43], v[196:197] op_sel:[0,0,0] op_sel_hi:[1,0,1]
    v_lshlrev_b32 v50, 16, v243
    v_and_b32 v51, 0xffff0000, v243
    v_pk_fma_f32 v[198:199], v[50:51], v[42:43], v[198:199] op_sel:[0,0,0] op_sel_hi:[1,0,1]
    v_lshlrev_b32 v48, 16, v244
    v_and_b32 v49, 0xffff0000, v244
    v_pk_fma_f32 v[200:201], v[48:49], v[42:43], v[200:201] op_sel:[0,0,0] op_sel_hi:[1,0,1]
    v_lshlrev_b32 v50, 16, v245
    v_and_b32 v51, 0xffff0000, v245
    v_pk_fma_f32 v[202:203], v[50:51], v[42:43], v[202:203] op_sel:[0,0,0] op_sel_hi:[1,0,1]
    v_lshlrev_b32 v48, 16, v246
    v_and_b32 v49, 0xffff0000, v246
    v_pk_fma_f32 v[204:205], v[48:49], v[42:43], v[204:205] op_sel:[0,0,0] op_sel_hi:[1,0,1]
    v_lshlrev_b32 v50, 16, v247
    v_and_b32 v51, 0xffff0000, v247
    v_pk_fma_f32 v[206:207], v[50:51], v[42:43], v[206:207] op_sel:[0,0,0] op_sel_hi:[1,0,1]
    v_lshlrev_b32 v48, 16, v248
    v_and_b32 v49, 0xffff0000, v248
    v_pk_fma_f32 v[208:209], v[48:49], v[42:43], v[208:209] op_sel:[0,0,0] op_sel_hi:[1,0,1]
    v_lshlrev_b32 v50, 16, v249
    v_and_b32 v51, 0xffff0000, v249
    v_pk_fma_f32 v[210:211], v[50:51], v[42:43], v[210:211] op_sel:[0,0,0] op_sel_hi:[1,0,1]
    v_lshlrev_b32 v48, 16, v250
    v_and_b32 v49, 0xffff0000, v250
    v_pk_fma_f32 v[212:213], v[48:49], v[42:43], v[212:213] op_sel:[0,0,0] op_sel_hi:[1,0,1]
    v_lshlrev_b32 v50, 16, v251
    v_and_b32 v51, 0xffff0000, v251
    v_pk_fma_f32 v[214:215], v[50:51], v[42:43], v[214:215] op_sel:[0,0,0] op_sel_hi:[1,0,1]
    v_lshlrev_b32 v48, 16, v252
    v_and_b32 v49, 0xffff0000, v252
    v_pk_fma_f32 v[216:217], v[48:49], v[42:43], v[216:217] op_sel:[0,0,0] op_sel_hi:[1,0,1]
    v_lshlrev_b32 v50, 16, v253
    v_and_b32 v51, 0xffff0000, v253
    v_pk_fma_f32 v[218:219], v[50:51], v[42:43], v[218:219] op_sel:[0,0,0] op_sel_hi:[1,0,1]
    v_lshlrev_b32 v48, 16, v254
    v_and_b32 v49, 0xffff0000, v254
    v_pk_fma_f32 v[220:221], v[48:49], v[42:43], v[220:221] op_sel:[0,0,0] op_sel_hi:[1,0,1]
    v_lshlrev_b32 v50, 16, v255
    v_and_b32 v51, 0xffff0000, v255
    v_pk_fma_f32 v[222:223], v[50:51], v[42:43], v[222:223] op_sel:[0,0,0] op_sel_hi:[1,0,1]
    s_waitcnt vmcnt(0)
    v_lshlrev_b32 v48, 16, v64
    v_and_b32 v49, 0xffff0000, v64
    v_pk_fma_f32 v[192:193], v[48:49], v[42:43], v[192:193] op_sel:[0,1,0] op_sel_hi:[1,1,1]
    v_lshlrev_b32 v50, 16, v65
    v_and_b32 v51, 0xffff0000, v65
    v_pk_fma_f32 v[194:195], v[50:51], v[42:43], v[194:195] op_sel:[0,1,0] op_sel_hi:[1,1,1]
    v_lshlrev_b32 v48, 16, v66
    v_and_b32 v49, 0xffff0000, v66
    v_pk_fma_f32 v[196:197], v[48:49], v[42:43], v[196:197] op_sel:[0,1,0] op_sel_hi:[1,1,1]
    v_lshlrev_b32 v50, 16, v67
    v_and_b32 v51, 0xffff0000, v67
    v_pk_fma_f32 v[198:199], v[50:51], v[42:43], v[198:199] op_sel:[0,1,0] op_sel_hi:[1,1,1]
    v_lshlrev_b32 v48, 16, v68
    v_and_b32 v49, 0xffff0000, v68
    v_pk_fma_f32 v[200:201], v[48:49], v[42:43], v[200:201] op_sel:[0,1,0] op_sel_hi:[1,1,1]
    v_lshlrev_b32 v50, 16, v69
    v_and_b32 v51, 0xffff0000, v69
    v_pk_fma_f32 v[202:203], v[50:51], v[42:43], v[202:203] op_sel:[0,1,0] op_sel_hi:[1,1,1]
    v_lshlrev_b32 v48, 16, v70
    v_and_b32 v49, 0xffff0000, v70
    v_pk_fma_f32 v[204:205], v[48:49], v[42:43], v[204:205] op_sel:[0,1,0] op_sel_hi:[1,1,1]
    v_lshlrev_b32 v50, 16, v71
    v_and_b32 v51, 0xffff0000, v71
    v_pk_fma_f32 v[206:207], v[50:51], v[42:43], v[206:207] op_sel:[0,1,0] op_sel_hi:[1,1,1]
    v_lshlrev_b32 v48, 16, v72
    v_and_b32 v49, 0xffff0000, v72
    v_pk_fma_f32 v[208:209], v[48:49], v[42:43], v[208:209] op_sel:[0,1,0] op_sel_hi:[1,1,1]
    v_lshlrev_b32 v50, 16, v73
    v_and_b32 v51, 0xffff0000, v73
    v_pk_fma_f32 v[210:211], v[50:51], v[42:43], v[210:211] op_sel:[0,1,0] op_sel_hi:[1,1,1]
    v_lshlrev_b32 v48, 16, v74
    v_and_b32 v49, 0xffff0000, v74
    v_pk_fma_f32 v[212:213], v[48:49], v[42:43], v[212:213] op_sel:[0,1,0] op_sel_hi:[1,1,1]
    v_lshlrev_b32 v50, 16, v75
    v_and_b32 v51, 0xffff0000, v75
    v_pk_fma_f32 v[214:215], v[50:51], v[42:43], v[214:215] op_sel:[0,1,0] op_sel_hi:[1,1,1]
    v_lshlrev_b32 v48, 16, v76
    v_and_b32 v49, 0xffff0000, v76
    v_pk_fma_f32 v[216:217], v[48:49], v[42:43], v[216:217] op_sel:[0,1,0] op_sel_hi:[1,1,1]
    v_lshlrev_b32 v50, 16, v77
    v_and_b32 v51, 0xffff0000, v77
    v_pk_fma_f32 v[218:219], v[50:51], v[42:43], v[218:219] op_sel:[0,1,0] op_sel_hi:[1,1,1]
    v_lshlrev_b32 v48, 16, v78
    v_and_b32 v49, 0xffff0000, v78
    v_pk_fma_f32 v[220:221], v[48:49], v[42:43], v[220:221] op_sel:[0,1,0] op_sel_hi:[1,1,1]
    v_lshlrev_b32 v50, 16, v79
    v_and_b32 v51, 0xffff0000, v79
    v_pk_fma_f32 v[222:223], v[50:51], v[42:43], v[222:223] op_sel:[0,1,0] op_sel_hi:[1,1,1]
    v_cvt_pk_bf16_f32 v80, v192, v193
    v_cvt_pk_bf16_f32 v81, v194, v195
    v_cvt_pk_bf16_f32 v82, v196, v197
    v_cvt_pk_bf16_f32 v83, v198, v199
    v_cvt_pk_bf16_f32 v84, v200, v201
    v_cvt_pk_bf16_f32 v85, v202, v203
    v_cvt_pk_bf16_f32 v86, v204, v205
    v_cvt_pk_bf16_f32 v87, v206, v207
    v_permlane32_swap_b32 v80, v82
    v_permlane32_swap_b32 v81, v83
    v_permlane32_swap_b32 v84, v86
    v_permlane32_swap_b32 v85, v87
    buffer_store_dwordx4 v[80:83], v44, s[48:51], s73 offen offset:0 sc1
    buffer_store_dwordx4 v[84:87], v44, s[48:51], s73 offen offset:512 sc1
    v_cvt_pk_bf16_f32 v88, v208, v209
    v_cvt_pk_bf16_f32 v89, v210, v211
    v_cvt_pk_bf16_f32 v90, v212, v213
    v_cvt_pk_bf16_f32 v91, v214, v215
    v_cvt_pk_bf16_f32 v92, v216, v217
    v_cvt_pk_bf16_f32 v93, v218, v219
    v_cvt_pk_bf16_f32 v94, v220, v221
    v_cvt_pk_bf16_f32 v95, v222, v223
    v_permlane32_swap_b32 v88, v90
    v_permlane32_swap_b32 v89, v91
    v_permlane32_swap_b32 v92, v94
    v_permlane32_swap_b32 v93, v95
    buffer_store_dwordx4 v[88:91], v44, s[48:51], s73 offen offset:2048 sc1
    buffer_store_dwordx4 v[92:95], v44, s[48:51], s73 offen offset:2560 sc1
    v_mov_b32 v28, s62
    v_mov_b32 v29, s63
    v_mov_b32 v30, 0
    s_mov_b64 exec, 1
    s_waitcnt vmcnt(0)
    buffer_store_dwordx2 v[28:29], v30, s[48:51], s74 offen sc1
    s_mov_b64 exec, -1
L_t1done_39:
    s_lshl_b32 s75, s85, 16
    s_add_u32 s75, s75, s82
    s_add_u32 s75, s75, 8192
    buffer_load_dwordx4 v[144:147], v8, s[36:39], s75 offen offset:0
    buffer_load_dwordx4 v[148:151], v8, s[36:39], s75 offen offset:2048
    s_add_u32 s75, s75, 4096
    buffer_load_dwordx4 v[152:155], v8, s[36:39], s75 offen offset:0
    buffer_load_dwordx4 v[156:159], v8, s[36:39], s75 offen offset:2048
    s_lshl_b32 s75, s86, 16
    s_add_u32 s75, s75, s82
    buffer_load_dwordx4 v[96:99], v8, s[36:39], s75 offen offset:0
    buffer_load_dwordx4 v[100:103], v8, s[36:39], s75 offen offset:2048
    s_add_u32 s75, s75, 4096
    buffer_load_dwordx4 v[104:107], v8, s[36:39], s75 offen offset:0
    buffer_load_dwordx4 v[108:111], v8, s[36:39], s75 offen offset:2048
    s_add_u32 s75, s75, 4096
    buffer_load_dwordx4 v[112:115], v8, s[36:39], s75 offen offset:0
    buffer_load_dwordx4 v[116:119], v8, s[36:39], s75 offen offset:2048
    s_add_u32 s75, s75, 4096
    buffer_load_dwordx4 v[120:123], v8, s[36:39], s75 offen offset:0
    buffer_load_dwordx4 v[124:127], v8, s[36:39], s75 offen offset:2048
    s_lshl_b32 s75, s87, 16
    s_add_u32 s75, s75, s82
    buffer_load_dwordx4 v[224:227], v8, s[36:39], s75 offen offset:0
    buffer_load_dwordx4 v[228:231], v8, s[36:39], s75 offen offset:2048
    s_add_u32 s75, s75, 4096
    buffer_load_dwordx4 v[232:235], v8, s[36:39], s75 offen offset:0
    buffer_load_dwordx4 v[236:239], v8, s[36:39], s75 offen offset:2048
    s_add_u32 s75, s75, 4096
    buffer_load_dwordx4 v[240:243], v8, s[36:39], s75 offen offset:0
    buffer_load_dwordx4 v[244:247], v8, s[36:39], s75 offen offset:2048
    s_add_u32 s75, s75, 4096
    buffer_load_dwordx4 v[248:251], v8, s[36:39], s75 offen offset:0
    buffer_load_dwordx4 v[252:255], v8, s[36:39], s75 offen offset:2048
    s_waitcnt vmcnt(24)
    v_perm_b32 v192, v164, v160, s69
    v_perm_b32 v193, v172, v168, s69
    v_perm_b32 v194, v180, v176, s69
    v_perm_b32 v195, v188, v184, s69
    v_perm_b32 v196, v164, v160, s70
    v_perm_b32 v197, v172, v168, s70
    v_perm_b32 v198, v180, v176, s70
    v_perm_b32 v199, v188, v184, s70
    v_perm_b32 v200, v165, v161, s69
    v_perm_b32 v201, v173, v169, s69
    v_perm_b32 v202, v181, v177, s69
    v_perm_b32 v203, v189, v185, s69
    v_perm_b32 v204, v165, v161, s70
    v_perm_b32 v205, v173, v169, s70
    v_perm_b32 v206, v181, v177, s70
    v_perm_b32 v207, v189, v185, s70
    v_perm_b32 v208, v166, v162, s69
    v_perm_b32 v209, v174, v170, s69
    v_perm_b32 v210, v182, v178, s69
    v_perm_b32 v211, v190, v186, s69
    v_perm_b32 v212, v166, v162, s70
    v_perm_b32 v213, v174, v170, s70
    v_perm_b32 v214, v182, v178, s70
    v_perm_b32 v215, v190, v186, s70
    v_perm_b32 v216, v167, v163, s69
    v_perm_b32 v217, v175, v171, s69
    v_perm_b32 v218, v183, v179, s69
    v_perm_b32 v219, v191, v187, s69
    v_perm_b32 v220, v167, v163, s70
    v_perm_b32 v221, v175, v171, s70
    v_perm_b32 v222, v183, v179, s70
    v_perm_b32 v223, v191, v187, s70
    s_waitcnt vmcnt(16)
    v_perm_b32 v160, v132, v128, s69
    v_perm_b32 v161, v140, v136, s69
    v_perm_b32 v162, v148, v144, s69
    v_perm_b32 v163, v156, v152, s69
    v_perm_b32 v164, v132, v128, s70
    v_perm_b32 v165, v140, v136, s70
    v_perm_b32 v166, v148, v144, s70
    v_perm_b32 v167, v156, v152, s70
    v_perm_b32 v168, v133, v129, s69
    v_perm_b32 v169, v141, v137, s69
    v_perm_b32 v170, v149, v145, s69
    v_perm_b32 v171, v157, v153, s69
    v_perm_b32 v172, v133, v129, s70
    v_perm_b32 v173, v141, v137, s70
    v_perm_b32 v174, v149, v145, s70
    v_perm_b32 v175, v157, v153, s70
    v_perm_b32 v176, v134, v130, s69
    v_perm_b32 v177, v142, v138, s69
    v_perm_b32 v178, v150, v146, s69
    v_perm_b32 v179, v158, v154, s69
    v_perm_b32 v180, v134, v130, s70
    v_perm_b32 v181, v142, v138, s70
    v_perm_b32 v182, v150, v146, s70
    v_perm_b32 v183, v158, v154, s70
    v_perm_b32 v184, v135, v131, s69
    v_perm_b32 v185, v143, v139, s69
    v_perm_b32 v186, v151, v147, s69
    v_perm_b32 v187, v159, v155, s69
    v_perm_b32 v188, v135, v131, s70
    v_perm_b32 v189, v143, v139, s70
    v_perm_b32 v190, v151, v147, s70
    v_perm_b32 v191, v159, v155, s70
    s_waitcnt vmcnt(8)
    v_perm_b32 v128, v100, v96, s69
    v_perm_b32 v129, v108, v104, s69
    v_perm_b32 v130, v116, v112, s69
    v_perm_b32 v131, v124, v120, s69
    v_perm_b32 v132, v100, v96, s70
    v_perm_b32 v133, v108, v104, s70
    v_perm_b32 v134, v116, v112, s70
    v_perm_b32 v135, v124, v120, s70
    v_perm_b32 v136, v101, v97, s69
    v_perm_b32 v137, v109, v105, s69
    v_perm_b32 v138, v117, v113, s69
    v_perm_b32 v139, v125, v121, s69
    v_perm_b32 v140, v101, v97, s70
    v_perm_b32 v141, v109, v105, s70
    v_perm_b32 v142, v117, v113, s70
    v_perm_b32 v143, v125, v121, s70
    v_perm_b32 v144, v102, v98, s69
    v_perm_b32 v145, v110, v106, s69
    v_perm_b32 v146, v118, v114, s69
    v_perm_b32 v147, v126, v122, s69
    v_perm_b32 v148, v102, v98, s70
    v_perm_b32 v149, v110, v106, s70
    v_perm_b32 v150, v118, v114, s70
    v_perm_b32 v151, v126, v122, s70
    v_perm_b32 v152, v103, v99, s69
    v_perm_b32 v153, v111, v107, s69
    v_perm_b32 v154, v119, v115, s69
    v_perm_b32 v155, v127, v123, s69
    v_perm_b32 v156, v103, v99, s70
    v_perm_b32 v157, v111, v107, s70
    v_perm_b32 v158, v119, v115, s70
    v_perm_b32 v159, v127, v123, s70
    s_waitcnt vmcnt(0)
    v_perm_b32 v96, v228, v224, s69
    v_perm_b32 v97, v236, v232, s69
    v_perm_b32 v98, v244, v240, s69
    v_perm_b32 v99, v252, v248, s69
    v_perm_b32 v100, v228, v224, s70
    v_perm_b32 v101, v236, v232, s70
    v_perm_b32 v102, v244, v240, s70
    v_perm_b32 v103, v252, v248, s70
    v_perm_b32 v104, v229, v225, s69
    v_perm_b32 v105, v237, v233, s69
    v_perm_b32 v106, v245, v241, s69
    v_perm_b32 v107, v253, v249, s69
    v_perm_b32 v108, v229, v225, s70
    v_perm_b32 v109, v237, v233, s70
    v_perm_b32 v110, v245, v241, s70
    v_perm_b32 v111, v253, v249, s70
    v_perm_b32 v112, v230, v226, s69
    v_perm_b32 v113, v238, v234, s69
    v_perm_b32 v114, v246, v242, s69
    v_perm_b32 v115, v254, v250, s69
    v_perm_b32 v116, v230, v226, s70
    v_perm_b32 v117, v238, v234, s70
    v_perm_b32 v118, v246, v242, s70
    v_perm_b32 v119, v254, v250, s70
    v_perm_b32 v120, v231, v227, s69
    v_perm_b32 v121, v239, v235, s69
    v_perm_b32 v122, v247, v243, s69
    v_perm_b32 v123, v255, v251, s69
    v_perm_b32 v124, v231, v227, s70
    v_perm_b32 v125, v239, v235, s70
    v_perm_b32 v126, v247, v243, s70
    v_perm_b32 v127, v255, v251, s70
    s_lshl_b32 s72, s60, 2
    s_add_u32 s72, s72, s56
    s_lshl_b32 s72, s72, 3
    s_add_u32 s72, s72, s52
    s_lshl_b32 s73, s72, 8
    s_add_u32 s73, s73, 917504
    s_lshl_b32 s72, s72, 13
    s_add_u32 s72, s72, 17825792
    s_lshl_b32 s76, s64, 10
    v_add_u32 v16, s76, v15
    v_xor_b32 v17, 0x400, v16
    s_lshl_b32 s84, s84, 11
    s_add_u32 s84, s84, s72
    s_lshl_b32 s85, s85, 11
    s_add_u32 s85, s85, s72
    s_lshl_b32 s86, s86, 11
    s_add_u32 s86, s86, s72
    s_lshl_b32 s87, s87, 11
    s_add_u32 s87, s87, s72
    s_mul_i32 s94, s64, 81920
    s_sub_u32 s95, 81920, s94
    s_mul_i32 s96, s71, 14336
    s_add_u32 s95, s95, s96
    s_add_u32 s96, s96, s94
    v_add_u32 v9, s96, v15
    v_add_u32 v10, s95, v15
    s_xor_b32 s96, s71, 2
    s_mul_i32 s96, s96, 14336
    s_add_u32 s96, s96, s94
    v_add_u32 v11, s96, v15
    s_xor_b32 s96, s71, 1
    s_mul_i32 s96, s96, 14336
    s_add_u32 s96, s96, s94
    v_add_u32 v12, s96, v15
    s_lshl_b32 s9, s60, 3
    s_add_u32 s9, s9, s59
    s_lshl_b32 s9, s9, 2
    s_add_u32 s9, s9, s56
    s_lshl_b32 s8, s9, 10
    s_add_u32 s8, s8, 393216
    s_lshl_b32 s75, s52, 7
    s_add_u32 s8, s8, s75
    s_lshl_b32 s9, s9, 14
    s_add_u32 s9, s9, 12582912
    s_lshl_b32 s75, s52, 11
    v_add_u32 v20, s75, v15
    s_and_b32 s75, s56, 1
    s_lshl_b32 s75, s75, 3
    s_mov_b32 s12, 0x00ff00ff
    s_lshl_b32 s12, s12, s75
    s_mov_b32 s13, s12
    s_lshr_b32 s11, s56, 1
    s_cmp_eq_u32 s64, s11
    s_cselect_b64 s[14:15], s[12:13], 0
    s_not_b64 s[14:15], s[14:15]
    s_lshl_b32 s10, s60, 1
    s_add_u32 s10, s10, s64
    s_lshl_b32 s10, s10, 15
    s_lshl_b32 s75, s59, 8
    s_add_u32 s10, s10, s75
    s_lshl_b32 s75, s71, 4
    s_add_u32 s10, s10, s75
    v_lshlrev_b32 v21, 11, v14
    v_lshl_add_u32 v21, v13, 6, v21
    s_xor_b32 s78, s8, 1024
    s_xor_b32 s81, s9, 16384
    s_xor_b32 s79, s8, 2048
    s_xor_b32 s82, s9, 32768
    s_xor_b32 s80, s8, 3072
    s_xor_b32 s83, s9, 49152
    s_mov_b32 s77, 0
L_poll_50:
    s_load_dwordx2 s[4:5], s[18:19], s73 glc
    s_load_dwordx2 s[6:7], s[18:19], s73 offset:128 glc
    s_waitcnt lgkmcnt(0)
    s_mov_b32 s76, 1
    s_cmp_eq_u64 s[4:5], s[62:63]
    s_cselect_b32 s76, s76, 0
    s_cmp_eq_u64 s[6:7], s[62:63]
    s_cselect_b32 s76, s76, 0
    s_cmp_lg_u32 s76, 0
    s_cbranch_scc1 L_polld_51
    s_add_u32 s77, s77, 1
    s_cmp_lt_u32 s77, 40000
    s_cbranch_scc1 L_poll_50
L_polld_51:
    buffer_load_dwordx4 v[80:83], v17, s[48:51], s84 offen sc1
    buffer_load_dwordx4 v[84:87], v17, s[48:51], s85 offen sc1
    buffer_load_dwordx4 v[88:91], v17, s[48:51], s86 offen sc1
    buffer_load_dwordx4 v[92:95], v17, s[48:51], s87 offen sc1
    buffer_load_dwordx4 v[64:67], v16, s[48:51], s84 offen sc1
    buffer_load_dwordx4 v[68:71], v16, s[48:51], s85 offen sc1
    buffer_load_dwordx4 v[72:75], v16, s[48:51], s86 offen sc1
    buffer_load_dwordx4 v[76:79], v16, s[48:51], s87 offen sc1
    s_waitcnt vmcnt(7)
    v_mfma_f32_16x16x32_bf16 v[224:227], v[192:195], v[80:83], 0
    v_mfma_f32_16x16x32_bf16 v[228:231], v[196:199], v[80:83], 0
    v_mfma_f32_16x16x32_bf16 v[232:235], v[200:203], v[80:83], 0
    v_mfma_f32_16x16x32_bf16 v[236:239], v[204:207], v[80:83], 0
    v_mfma_f32_16x16x32_bf16 v[240:243], v[208:211], v[80:83], 0
    v_mfma_f32_16x16x32_bf16 v[244:247], v[212:215], v[80:83], 0
    v_mfma_f32_16x16x32_bf16 v[248:251], v[216:219], v[80:83], 0
    v_mfma_f32_16x16x32_bf16 v[252:255], v[220:223], v[80:83], 0
    s_waitcnt vmcnt(6)
    v_mfma_f32_16x16x32_bf16 v[224:227], v[160:163], v[84:87], v[224:227]
    v_mfma_f32_16x16x32_bf16 v[228:231], v[164:167], v[84:87], v[228:231]
    v_mfma_f32_16x16x32_bf16 v[232:235], v[168:171], v[84:87], v[232:235]
    v_mfma_f32_16x16x32_bf16 v[236:239], v[172:175], v[84:87], v[236:239]
    v_mfma_f32_16x16x32_bf16 v[240:243], v[176:179], v[84:87], v[240:243]
    v_mfma_f32_16x16x32_bf16 v[244:247], v[180:183], v[84:87], v[244:247]
    v_mfma_f32_16x16x32_bf16 v[248:251], v[184:187], v[84:87], v[248:251]
    v_mfma_f32_16x16x32_bf16 v[252:255], v[188:191], v[84:87], v[252:255]
    s_waitcnt vmcnt(5)
    v_mfma_f32_16x16x32_bf16 v[224:227], v[128:131], v[88:91], v[224:227]
    v_mfma_f32_16x16x32_bf16 v[228:231], v[132:135], v[88:91], v[228:231]
    v_mfma_f32_16x16x32_bf16 v[232:235], v[136:139], v[88:91], v[232:235]
    v_mfma_f32_16x16x32_bf16 v[236:239], v[140:143], v[88:91], v[236:239]
    v_mfma_f32_16x16x32_bf16 v[240:243], v[144:147], v[88:91], v[240:243]
    v_mfma_f32_16x16x32_bf16 v[244:247], v[148:151], v[88:91], v[244:247]
    v_mfma_f32_16x16x32_bf16 v[248:251], v[152:155], v[88:91], v[248:251]
    v_mfma_f32_16x16x32_bf16 v[252:255], v[156:159], v[88:91], v[252:255]
    s_waitcnt vmcnt(4)
    v_mfma_f32_16x16x32_bf16 v[224:227], v[96:99], v[92:95], v[224:227]
    v_mfma_f32_16x16x32_bf16 v[228:231], v[100:103], v[92:95], v[228:231]
    v_mfma_f32_16x16x32_bf16 v[232:235], v[104:107], v[92:95], v[232:235]
    v_mfma_f32_16x16x32_bf16 v[236:239], v[108:111], v[92:95], v[236:239]
    v_mfma_f32_16x16x32_bf16 v[240:243], v[112:115], v[92:95], v[240:243]
    v_mfma_f32_16x16x32_bf16 v[244:247], v[116:119], v[92:95], v[244:247]
    v_mfma_f32_16x16x32_bf16 v[248:251], v[120:123], v[92:95], v[248:251]
    v_mfma_f32_16x16x32_bf16 v[252:255], v[124:127], v[92:95], v[252:255]
    s_waitcnt vmcnt(0)
    v_mfma_f32_16x16x32_bf16 v[32:35], v[192:195], v[64:67], 0
    v_mfma_f32_16x16x32_bf16 v[36:39], v[196:199], v[64:67], 0
    v_mfma_f32_16x16x32_bf16 v[40:43], v[200:203], v[64:67], 0
    v_mfma_f32_16x16x32_bf16 v[44:47], v[204:207], v[64:67], 0
    v_mfma_f32_16x16x32_bf16 v[48:51], v[208:211], v[64:67], 0
    v_mfma_f32_16x16x32_bf16 v[52:55], v[212:215], v[64:67], 0
    v_mfma_f32_16x16x32_bf16 v[56:59], v[216:219], v[64:67], 0
    v_mfma_f32_16x16x32_bf16 v[60:63], v[220:223], v[64:67], 0
    v_mfma_f32_16x16x32_bf16 v[32:35], v[160:163], v[68:71], v[32:35]
    v_mfma_f32_16x16x32_bf16 v[36:39], v[164:167], v[68:71], v[36:39]
    v_mfma_f32_16x16x32_bf16 v[40:43], v[168:171], v[68:71], v[40:43]
    ds_write_b128 v9, v[224:227] offset:0
    v_mfma_f32_16x16x32_bf16 v[44:47], v[172:175], v[68:71], v[44:47]
    v_mfma_f32_16x16x32_bf16 v[48:51], v[176:179], v[68:71], v[48:51]
    v_mfma_f32_16x16x32_bf16 v[52:55], v[180:183], v[68:71], v[52:55]
    ds_write_b128 v9, v[228:231] offset:1024
    v_mfma_f32_16x16x32_bf16 v[56:59], v[184:187], v[68:71], v[56:59]
    v_mfma_f32_16x16x32_bf16 v[60:63], v[188:191], v[68:71], v[60:63]
    v_mfma_f32_16x16x32_bf16 v[32:35], v[128:131], v[72:75], v[32:35]
    ds_write_b128 v9, v[232:235] offset:2048
    v_mfma_f32_16x16x32_bf16 v[36:39], v[132:135], v[72:75], v[36:39]
    v_mfma_f32_16x16x32_bf16 v[40:43], v[136:139], v[72:75], v[40:43]
    v_mfma_f32_16x16x32_bf16 v[44:47], v[140:143], v[72:75], v[44:47]
    ds_write_b128 v9, v[236:239] offset:3072
    v_mfma_f32_16x16x32_bf16 v[48:51], v[144:147], v[72:75], v[48:51]
    v_mfma_f32_16x16x32_bf16 v[52:55], v[148:151], v[72:75], v[52:55]
    v_mfma_f32_16x16x32_bf16 v[56:59], v[152:155], v[72:75], v[56:59]
    ds_write_b128 v9, v[240:243] offset:4096
    v_mfma_f32_16x16x32_bf16 v[60:63], v[156:159], v[72:75], v[60:63]
    v_mfma_f32_16x16x32_bf16 v[32:35], v[96:99], v[76:79], v[32:35]
    v_mfma_f32_16x16x32_bf16 v[36:39], v[100:103], v[76:79], v[36:39]
    ds_write_b128 v9, v[244:247] offset:5120
    v_mfma_f32_16x16x32_bf16 v[40:43], v[104:107], v[76:79], v[40:43]
    v_mfma_f32_16x16x32_bf16 v[44:47], v[108:111], v[76:79], v[44:47]
    v_mfma_f32_16x16x32_bf16 v[48:51], v[112:115], v[76:79], v[48:51]
    ds_write_b128 v9, v[248:251] offset:6144
    v_mfma_f32_16x16x32_bf16 v[52:55], v[116:119], v[76:79], v[52:55]
    v_mfma_f32_16x16x32_bf16 v[56:59], v[120:123], v[76:79], v[56:59]
    v_mfma_f32_16x16x32_bf16 v[60:63], v[124:127], v[76:79], v[60:63]
    ds_write_b128 v9, v[252:255] offset:7168
    s_waitcnt lgkmcnt(0)
    s_barrier
    ds_read_b128 v[96:99], v10 offset:0
    ds_read_b128 v[100:103], v10 offset:1024
    ds_read_b128 v[104:107], v10 offset:2048
    ds_read_b128 v[108:111], v10 offset:3072
    ds_read_b128 v[112:115], v10 offset:4096
    ds_read_b128 v[116:119], v10 offset:5120
    ds_read_b128 v[120:123], v10 offset:6144
    ds_read_b128 v[124:127], v10 offset:7168
    s_waitcnt lgkmcnt(7)
    v_add_f32 v176, v34, v98
    v_add_f32 v184, v35, v99
    v_add_f32 v160, v32, v96
    v_add_f32 v168, v33, v97
    s_waitcnt lgkmcnt(6)
    v_add_f32 v177, v38, v102
    v_add_f32 v185, v39, v103
    v_add_f32 v161, v36, v100
    v_add_f32 v169, v37, v101
    s_waitcnt lgkmcnt(5)
    v_add_f32 v178, v42, v106
    v_add_f32 v186, v43, v107
    v_add_f32 v162, v40, v104
    v_add_f32 v170, v41, v105
    s_waitcnt lgkmcnt(4)
    v_add_f32 v179, v46, v110
    v_add_f32 v187, v47, v111
    v_add_f32 v163, v44, v108
    v_add_f32 v171, v45, v109
    s_waitcnt lgkmcnt(3)
    v_add_f32 v180, v50, v114
    v_add_f32 v188, v51, v115
    v_add_f32 v164, v48, v112
    v_add_f32 v172, v49, v113
    s_waitcnt lgkmcnt(2)
    v_add_f32 v181, v54, v118
    v_add_f32 v189, v55, v119
    v_add_f32 v165, v52, v116
    v_add_f32 v173, v53, v117
    s_waitcnt lgkmcnt(1)
    v_add_f32 v182, v58, v122
    v_add_f32 v190, v59, v123
    v_add_f32 v166, v56, v120
    v_add_f32 v174, v57, v121
    s_waitcnt lgkmcnt(0)
    v_add_f32 v183, v62, v126
    v_add_f32 v191, v63, v127
    v_add_f32 v167, v60, v124
    v_add_f32 v175, v61, v125
    ds_write_b128 v9, v[176:179] offset:8192
    ds_write_b128 v9, v[180:183] offset:9216
    ds_write_b128 v9, v[184:187] offset:10240
    ds_write_b128 v9, v[188:191] offset:11264
    s_waitcnt lgkmcnt(0)
    s_barrier
    ds_read_b128 v[104:107], v11 offset:10240
    ds_read_b128 v[108:111], v11 offset:11264
    ds_read_b128 v[96:99], v11 offset:8192
    ds_read_b128 v[100:103], v11 offset:9216
    s_waitcnt lgkmcnt(2)
    v_pk_add_f32 v[168:169], v[168:169], v[104:105]
    v_pk_add_f32 v[170:171], v[170:171], v[106:107]
    v_pk_add_f32 v[172:173], v[172:173], v[108:109]
    v_pk_add_f32 v[174:175], v[174:175], v[110:111]
    ds_write_b128 v9, v[168:171] offset:12288
    ds_write_b128 v9, v[172:175] offset:13312
    s_waitcnt lgkmcnt(2)
    v_pk_add_f32 v[160:161], v[160:161], v[96:97]
    v_pk_add_f32 v[162:163], v[162:163], v[98:99]
    v_pk_add_f32 v[164:165], v[164:165], v[100:101]
    v_pk_add_f32 v[166:167], v[166:167], v[102:103]
    s_waitcnt lgkmcnt(0)
    s_barrier
    ds_read_b128 v[96:99], v12 offset:12288
    ds_read_b128 v[100:103], v12 offset:13312
    s_waitcnt lgkmcnt(0)
    v_pk_add_f32 v[160:161], v[160:161], v[96:97]
    v_pk_add_f32 v[162:163], v[162:163], v[98:99]
    v_pk_add_f32 v[164:165], v[164:165], v[100:101]
    v_pk_add_f32 v[166:167], v[166:167], v[102:103]
    s_mov_b64 exec, s[14:15]
    buffer_store_dwordx4 v[160:163], v20, s[48:51], s9 offen sc1
    buffer_store_dwordx4 v[164:167], v20, s[48:51], s9 offen offset:1024 sc1
    s_mov_b64 exec, -1
    v_mov_b32 v28, s62
    v_mov_b32 v29, s63
    v_mov_b32 v30, 0
    s_mov_b64 exec, 1
    s_waitcnt vmcnt(0)
    buffer_store_dwordx2 v[28:29], v30, s[48:51], s8 offen sc1
    s_mov_b64 exec, -1
    s_cmp_lg_u32 s64, s11
    s_cbranch_scc1 L_rend_52
    s_mov_b32 s77, 0
L_poll_53:
    s_load_dwordx2 s[92:93], s[18:19], s78 glc
    s_load_dwordx2 s[94:95], s[18:19], s79 glc
    s_load_dwordx2 s[96:97], s[18:19], s80 glc
    s_waitcnt lgkmcnt(0)
    s_mov_b32 s76, 1
    s_cmp_eq_u64 s[92:93], s[62:63]
    s_cselect_b32 s76, s76, 0
    s_cmp_eq_u64 s[94:95], s[62:63]
    s_cselect_b32 s76, s76, 0
    s_cmp_eq_u64 s[96:97], s[62:63]
    s_cselect_b32 s76, s76, 0
    s_cmp_lg_u32 s76, 0
    s_cbranch_scc1 L_polld_54
    s_add_u32 s77, s77, 1
    s_cmp_lt_u32 s77, 40000
    s_cbranch_scc1 L_poll_53
L_polld_54:
    s_mov_b64 exec, s[12:13]
    buffer_load_dwordx4 v[96:99], v20, s[48:51], s81 offen sc1
    buffer_load_dwordx4 v[100:103], v20, s[48:51], s81 offen offset:1024 sc1
    buffer_load_dwordx4 v[104:107], v20, s[48:51], s82 offen sc1
    buffer_load_dwordx4 v[108:111], v20, s[48:51], s82 offen offset:1024 sc1
    buffer_load_dwordx4 v[112:115], v20, s[48:51], s83 offen sc1
    buffer_load_dwordx4 v[116:119], v20, s[48:51], s83 offen offset:1024 sc1
    s_waitcnt vmcnt(4)
    v_pk_add_f32 v[160:161], v[160:161], v[96:97]
    v_pk_add_f32 v[162:163], v[162:163], v[98:99]
    v_pk_add_f32 v[164:165], v[164:165], v[100:101]
    v_pk_add_f32 v[166:167], v[166:167], v[102:103]
    s_waitcnt vmcnt(2)
    v_pk_add_f32 v[160:161], v[160:161], v[104:105]
    v_pk_add_f32 v[162:163], v[162:163], v[106:107]
    v_pk_add_f32 v[164:165], v[164:165], v[108:109]
    v_pk_add_f32 v[166:167], v[166:167], v[110:111]
    s_waitcnt vmcnt(0)
    v_pk_add_f32 v[160:161], v[160:161], v[112:113]
    v_pk_add_f32 v[162:163], v[162:163], v[114:115]
    v_pk_add_f32 v[164:165], v[164:165], v[116:117]
    v_pk_add_f32 v[166:167], v[166:167], v[118:119]
    v_cvt_pk_bf16_f32 v124, v160, v161
    v_cvt_pk_bf16_f32 v125, v162, v163
    v_cvt_pk_bf16_f32 v126, v164, v165
    v_cvt_pk_bf16_f32 v127, v166, v167
    buffer_store_dwordx4 v[124:127], v21, s[40:43], s10 offen
    s_mov_b64 exec, -1
L_rend_52:
    s_endpgm
L_retry_7:
    s_mov_b32 s77, 0
L_rloop_9:
    s_nop 4
    buffer_load_dwordx4 v[160:163], v17, s[48:51], s74 offen offset:0 sc1
    buffer_load_dwordx4 v[164:167], v17, s[48:51], s74 offen offset:1024 sc1
    buffer_load_dwordx4 v[168:171], v17, s[48:51], s74 offen offset:2048 sc1
    buffer_load_dwordx4 v[172:175], v17, s[48:51], s74 offen offset:3072 sc1
    buffer_load_dwordx4 v[176:179], v17, s[48:51], s73 offen offset:0 sc1
    buffer_load_dwordx4 v[180:183], v17, s[48:51], s73 offen offset:1024 sc1
    buffer_load_dwordx4 v[184:187], v17, s[48:51], s73 offen offset:2048 sc1
    buffer_load_dwordx4 v[188:191], v17, s[48:51], s73 offen offset:3072 sc1
    s_waitcnt vmcnt(0)
    v_max3_u32 v28, v160, v161, v162
    v_max3_u32 v28, v28, v163, v164
    v_max3_u32 v28, v28, v165, v166
    v_max3_u32 v28, v28, v167, v168
    v_max3_u32 v28, v28, v169, v170
    v_max3_u32 v28, v28, v171, v172
    v_max3_u32 v28, v28, v173, v174
    v_max3_u32 v28, v28, v175, v176
    v_max3_u32 v28, v28, v177, v178
    v_max3_u32 v28, v28, v179, v180
    v_max3_u32 v28, v28, v181, v182
    v_max3_u32 v28, v28, v183, v184
    v_max3_u32 v28, v28, v185, v186
    v_max3_u32 v28, v28, v187, v188
    v_max3_u32 v28, v28, v189, v190
    v_max_u32 v28, v28, v191
    v_cmp_eq_u32 vcc, -1, v28
    s_nop 4
    s_cbranch_vccz L_valid_8
    s_add_u32 s77, s77, 1
    s_cmp_lt_u32 s77, 40000
    s_cbranch_scc1 L_rloop_9
    s_branch L_valid_8
L_rare1_10:
    s_nop 4
    v_mov_b32 v29, v28
    s_nop 2
    v_permlane32_swap_b32 v29, v28
    s_nop 2
    v_max_f32 v28, v28, v29
    v_max_f32 v28, 0, v28
    v_sub_f32 v30, 0, v28
    v_exp_f32 v30, v30
    v_add_f32 v24, v24, v28
    s_nop 15
    v_sub_f32 v32, 0, v24
    v_sub_f32 v33, 0, v24
    v_sub_f32 v34, 0, v24
    v_sub_f32 v35, 0, v24
    v_sub_f32 v36, 0, v24
    v_sub_f32 v37, 0, v24
    v_sub_f32 v38, 0, v24
    v_sub_f32 v39, 0, v24
    v_sub_f32 v40, 0, v24
    v_sub_f32 v41, 0, v24
    v_sub_f32 v42, 0, v24
    v_sub_f32 v43, 0, v24
    v_sub_f32 v44, 0, v24
    v_sub_f32 v45, 0, v24
    v_sub_f32 v46, 0, v24
    v_sub_f32 v47, 0, v24
    v_sub_f32 v80, v80, v28
    v_sub_f32 v81, v81, v28
    v_sub_f32 v82, v82, v28
    v_sub_f32 v83, v83, v28
    v_sub_f32 v84, v84, v28
    v_sub_f32 v85, v85, v28
    v_sub_f32 v86, v86, v28
    v_sub_f32 v87, v87, v28
    v_sub_f32 v88, v88, v28
    v_sub_f32 v89, v89, v28
    v_sub_f32 v90, v90, v28
    v_sub_f32 v91, v91, v28
    v_sub_f32 v92, v92, v28
    v_sub_f32 v93, v93, v28
    v_sub_f32 v94, v94, v28
    v_sub_f32 v95, v95, v28
    v_mul_f32 v26, v26, v30
    v_mul_f32 v27, v27, v30
    s_mov_b32 s68, 1
    s_nop 4
    s_branch L_back1_11
L_rare2_12:
    s_nop 15
    v_mul_f32 v192, v192, v30
    v_mul_f32 v193, v193, v30
    v_mul_f32 v194, v194, v30
    v_mul_f32 v195, v195, v30
    v_mul_f32 v196, v196, v30
    v_mul_f32 v197, v197, v30
    v_mul_f32 v198, v198, v30
    v_mul_f32 v199, v199, v30
    v_mul_f32 v200, v200, v30
    v_mul_f32 v201, v201, v30
    v_mul_f32 v202, v202, v30
    v_mul_f32 v203, v203, v30
    v_mul_f32 v204, v204, v30
    v_mul_f32 v205, v205, v30
    v_mul_f32 v206, v206, v30
    v_mul_f32 v207, v207, v30
    v_mul_f32 v208, v208, v30
    v_mul_f32 v209, v209, v30
    v_mul_f32 v210, v210, v30
    v_mul_f32 v211, v211, v30
    v_mul_f32 v212, v212, v30
    v_mul_f32 v213, v213, v30
    v_mul_f32 v214, v214, v30
    v_mul_f32 v215, v215, v30
    v_mul_f32 v216, v216, v30
    v_mul_f32 v217, v217, v30
    v_mul_f32 v218, v218, v30
    v_mul_f32 v219, v219, v30
    v_mul_f32 v220, v220, v30
    v_mul_f32 v221, v221, v30
    v_mul_f32 v222, v222, v30
    v_mul_f32 v223, v223, v30
    v_mul_f32 v224, v224, v30
    v_mul_f32 v225, v225, v30
    v_mul_f32 v226, v226, v30
    v_mul_f32 v227, v227, v30
    v_mul_f32 v228, v228, v30
    v_mul_f32 v229, v229, v30
    v_mul_f32 v230, v230, v30
    v_mul_f32 v231, v231, v30
    v_mul_f32 v232, v232, v30
    v_mul_f32 v233, v233, v30
    v_mul_f32 v234, v234, v30
    v_mul_f32 v235, v235, v30
    v_mul_f32 v236, v236, v30
    v_mul_f32 v237, v237, v30
    v_mul_f32 v238, v238, v30
    v_mul_f32 v239, v239, v30
    v_mul_f32 v240, v240, v30
    v_mul_f32 v241, v241, v30
    v_mul_f32 v242, v242, v30
    v_mul_f32 v243, v243, v30
    v_mul_f32 v244, v244, v30
    v_mul_f32 v245, v245, v30
    v_mul_f32 v246, v246, v30
    v_mul_f32 v247, v247, v30
    v_mul_f32 v248, v248, v30
    v_mul_f32 v249, v249, v30
    v_mul_f32 v250, v250, v30
    v_mul_f32 v251, v251, v30
    v_mul_f32 v252, v252, v30
    v_mul_f32 v253, v253, v30
    v_mul_f32 v254, v254, v30
    v_mul_f32 v255, v255, v30
    s_mov_b32 s68, 0
    s_nop 4
    s_branch L_back2_13
L_rare1_14:
    s_nop 4
    v_mov_b32 v29, v28
    s_nop 2
    v_permlane32_swap_b32 v29, v28
    s_nop 2
    v_max_f32 v28, v28, v29
    v_max_f32 v28, 0, v28
    v_sub_f32 v30, 0, v28
    v_exp_f32 v30, v30
    v_add_f32 v24, v24, v28
    s_nop 15
    v_sub_f32 v32, 0, v24
    v_sub_f32 v33, 0, v24
    v_sub_f32 v34, 0, v24
    v_sub_f32 v35, 0, v24
    v_sub_f32 v36, 0, v24
    v_sub_f32 v37, 0, v24
    v_sub_f32 v38, 0, v24
    v_sub_f32 v39, 0, v24
    v_sub_f32 v40, 0, v24
    v_sub_f32 v41, 0, v24
    v_sub_f32 v42, 0, v24
    v_sub_f32 v43, 0, v24
    v_sub_f32 v44, 0, v24
    v_sub_f32 v45, 0, v24
    v_sub_f32 v46, 0, v24
    v_sub_f32 v47, 0, v24
    v_sub_f32 v64, v64, v28
    v_sub_f32 v65, v65, v28
    v_sub_f32 v66, v66, v28
    v_sub_f32 v67, v67, v28
    v_sub_f32 v68, v68, v28
    v_sub_f32 v69, v69, v28
    v_sub_f32 v70, v70, v28
    v_sub_f32 v71, v71, v28
    v_sub_f32 v72, v72, v28
    v_sub_f32 v73, v73, v28
    v_sub_f32 v74, v74, v28
    v_sub_f32 v75, v75, v28
    v_sub_f32 v76, v76, v28
    v_sub_f32 v77, v77, v28
    v_sub_f32 v78, v78, v28
    v_sub_f32 v79, v79, v28
    v_mul_f32 v26, v26, v30
    v_mul_f32 v27, v27, v30
    s_mov_b32 s68, 1
    s_nop 4
    s_branch L_back1_15
L_rare2_16:
    s_nop 15
    v_mul_f32 v192, v192, v30
    v_mul_f32 v193, v193, v30
    v_mul_f32 v194, v194, v30
    v_mul_f32 v195, v195, v30
    v_mul_f32 v196, v196, v30
    v_mul_f32 v197, v197, v30
    v_mul_f32 v198, v198, v30
    v_mul_f32 v199, v199, v30
    v_mul_f32 v200, v200, v30
    v_mul_f32 v201, v201, v30
    v_mul_f32 v202, v202, v30
    v_mul_f32 v203, v203, v30
    v_mul_f32 v204, v204, v30
    v_mul_f32 v205, v205, v30
    v_mul_f32 v206, v206, v30
    v_mul_f32 v207, v207, v30
    v_mul_f32 v208, v208, v30
    v_mul_f32 v209, v209, v30
    v_mul_f32 v210, v210, v30
    v_mul_f32 v211, v211, v30
    v_mul_f32 v212, v212, v30
    v_mul_f32 v213, v213, v30
    v_mul_f32 v214, v214, v30
    v_mul_f32 v215, v215, v30
    v_mul_f32 v216, v216, v30
    v_mul_f32 v217, v217, v30
    v_mul_f32 v218, v218, v30
    v_mul_f32 v219, v219, v30
    v_mul_f32 v220, v220, v30
    v_mul_f32 v221, v221, v30
    v_mul_f32 v222, v222, v30
    v_mul_f32 v223, v223, v30
    v_mul_f32 v224, v224, v30
    v_mul_f32 v225, v225, v30
    v_mul_f32 v226, v226, v30
    v_mul_f32 v227, v227, v30
    v_mul_f32 v228, v228, v30
    v_mul_f32 v229, v229, v30
    v_mul_f32 v230, v230, v30
    v_mul_f32 v231, v231, v30
    v_mul_f32 v232, v232, v30
    v_mul_f32 v233, v233, v30
    v_mul_f32 v234, v234, v30
    v_mul_f32 v235, v235, v30
    v_mul_f32 v236, v236, v30
    v_mul_f32 v237, v237, v30
    v_mul_f32 v238, v238, v30
    v_mul_f32 v239, v239, v30
    v_mul_f32 v240, v240, v30
    v_mul_f32 v241, v241, v30
    v_mul_f32 v242, v242, v30
    v_mul_f32 v243, v243, v30
    v_mul_f32 v244, v244, v30
    v_mul_f32 v245, v245, v30
    v_mul_f32 v246, v246, v30
    v_mul_f32 v247, v247, v30
    v_mul_f32 v248, v248, v30
    v_mul_f32 v249, v249, v30
    v_mul_f32 v250, v250, v30
    v_mul_f32 v251, v251, v30
    v_mul_f32 v252, v252, v30
    v_mul_f32 v253, v253, v30
    v_mul_f32 v254, v254, v30
    v_mul_f32 v255, v255, v30
    s_mov_b32 s68, 0
    s_nop 4
    s_branch L_back2_17
L_rare1_18:
    s_nop 4
    v_mov_b32 v29, v28
    s_nop 2
    v_permlane32_swap_b32 v29, v28
    s_nop 2
    v_max_f32 v28, v28, v29
    v_max_f32 v28, 0, v28
    v_sub_f32 v30, 0, v28
    v_exp_f32 v30, v30
    v_add_f32 v24, v24, v28
    s_nop 15
    v_sub_f32 v32, 0, v24
    v_sub_f32 v33, 0, v24
    v_sub_f32 v34, 0, v24
    v_sub_f32 v35, 0, v24
    v_sub_f32 v36, 0, v24
    v_sub_f32 v37, 0, v24
    v_sub_f32 v38, 0, v24
    v_sub_f32 v39, 0, v24
    v_sub_f32 v40, 0, v24
    v_sub_f32 v41, 0, v24
    v_sub_f32 v42, 0, v24
    v_sub_f32 v43, 0, v24
    v_sub_f32 v44, 0, v24
    v_sub_f32 v45, 0, v24
    v_sub_f32 v46, 0, v24
    v_sub_f32 v47, 0, v24
    v_sub_f32 v80, v80, v28
    v_sub_f32 v81, v81, v28
    v_sub_f32 v82, v82, v28
    v_sub_f32 v83, v83, v28
    v_sub_f32 v84, v84, v28
    v_sub_f32 v85, v85, v28
    v_sub_f32 v86, v86, v28
    v_sub_f32 v87, v87, v28
    v_sub_f32 v88, v88, v28
    v_sub_f32 v89, v89, v28
    v_sub_f32 v90, v90, v28
    v_sub_f32 v91, v91, v28
    v_sub_f32 v92, v92, v28
    v_sub_f32 v93, v93, v28
    v_sub_f32 v94, v94, v28
    v_sub_f32 v95, v95, v28
    v_mul_f32 v26, v26, v30
    v_mul_f32 v27, v27, v30
    s_mov_b32 s68, 1
    s_nop 4
    s_branch L_back1_19
L_rare2_20:
    s_nop 15
    v_mul_f32 v192, v192, v30
    v_mul_f32 v193, v193, v30
    v_mul_f32 v194, v194, v30
    v_mul_f32 v195, v195, v30
    v_mul_f32 v196, v196, v30
    v_mul_f32 v197, v197, v30
    v_mul_f32 v198, v198, v30
    v_mul_f32 v199, v199, v30
    v_mul_f32 v200, v200, v30
    v_mul_f32 v201, v201, v30
    v_mul_f32 v202, v202, v30
    v_mul_f32 v203, v203, v30
    v_mul_f32 v204, v204, v30
    v_mul_f32 v205, v205, v30
    v_mul_f32 v206, v206, v30
    v_mul_f32 v207, v207, v30
    v_mul_f32 v208, v208, v30
    v_mul_f32 v209, v209, v30
    v_mul_f32 v210, v210, v30
    v_mul_f32 v211, v211, v30
    v_mul_f32 v212, v212, v30
    v_mul_f32 v213, v213, v30
    v_mul_f32 v214, v214, v30
    v_mul_f32 v215, v215, v30
    v_mul_f32 v216, v216, v30
    v_mul_f32 v217, v217, v30
    v_mul_f32 v218, v218, v30
    v_mul_f32 v219, v219, v30
    v_mul_f32 v220, v220, v30
    v_mul_f32 v221, v221, v30
    v_mul_f32 v222, v222, v30
    v_mul_f32 v223, v223, v30
    v_mul_f32 v224, v224, v30
    v_mul_f32 v225, v225, v30
    v_mul_f32 v226, v226, v30
    v_mul_f32 v227, v227, v30
    v_mul_f32 v228, v228, v30
    v_mul_f32 v229, v229, v30
    v_mul_f32 v230, v230, v30
    v_mul_f32 v231, v231, v30
    v_mul_f32 v232, v232, v30
    v_mul_f32 v233, v233, v30
    v_mul_f32 v234, v234, v30
    v_mul_f32 v235, v235, v30
    v_mul_f32 v236, v236, v30
    v_mul_f32 v237, v237, v30
    v_mul_f32 v238, v238, v30
    v_mul_f32 v239, v239, v30
    v_mul_f32 v240, v240, v30
    v_mul_f32 v241, v241, v30
    v_mul_f32 v242, v242, v30
    v_mul_f32 v243, v243, v30
    v_mul_f32 v244, v244, v30
    v_mul_f32 v245, v245, v30
    v_mul_f32 v246, v246, v30
    v_mul_f32 v247, v247, v30
    v_mul_f32 v248, v248, v30
    v_mul_f32 v249, v249, v30
    v_mul_f32 v250, v250, v30
    v_mul_f32 v251, v251, v30
    v_mul_f32 v252, v252, v30
    v_mul_f32 v253, v253, v30
    v_mul_f32 v254, v254, v30
    v_mul_f32 v255, v255, v30
    s_mov_b32 s68, 0
    s_nop 4
    s_branch L_back2_21
L_rare1_22:
    s_nop 4
    v_mov_b32 v29, v28
    s_nop 2
    v_permlane32_swap_b32 v29, v28
    s_nop 2
    v_max_f32 v28, v28, v29
    v_max_f32 v28, 0, v28
    v_sub_f32 v30, 0, v28
    v_exp_f32 v30, v30
    v_add_f32 v24, v24, v28
    s_nop 15
    v_sub_f32 v32, 0, v24
    v_sub_f32 v33, 0, v24
    v_sub_f32 v34, 0, v24
    v_sub_f32 v35, 0, v24
    v_sub_f32 v36, 0, v24
    v_sub_f32 v37, 0, v24
    v_sub_f32 v38, 0, v24
    v_sub_f32 v39, 0, v24
    v_sub_f32 v40, 0, v24
    v_sub_f32 v41, 0, v24
    v_sub_f32 v42, 0, v24
    v_sub_f32 v43, 0, v24
    v_sub_f32 v44, 0, v24
    v_sub_f32 v45, 0, v24
    v_sub_f32 v46, 0, v24
    v_sub_f32 v47, 0, v24
    v_sub_f32 v64, v64, v28
    v_sub_f32 v65, v65, v28
    v_sub_f32 v66, v66, v28
    v_sub_f32 v67, v67, v28
    v_sub_f32 v68, v68, v28
    v_sub_f32 v69, v69, v28
    v_sub_f32 v70, v70, v28
    v_sub_f32 v71, v71, v28
    v_sub_f32 v72, v72, v28
    v_sub_f32 v73, v73, v28
    v_sub_f32 v74, v74, v28
    v_sub_f32 v75, v75, v28
    v_sub_f32 v76, v76, v28
    v_sub_f32 v77, v77, v28
    v_sub_f32 v78, v78, v28
    v_sub_f32 v79, v79, v28
    v_mul_f32 v26, v26, v30
    v_mul_f32 v27, v27, v30
    s_mov_b32 s68, 1
    s_nop 4
    s_branch L_back1_23
L_rare2_24:
    s_nop 15
    v_mul_f32 v192, v192, v30
    v_mul_f32 v193, v193, v30
    v_mul_f32 v194, v194, v30
    v_mul_f32 v195, v195, v30
    v_mul_f32 v196, v196, v30
    v_mul_f32 v197, v197, v30
    v_mul_f32 v198, v198, v30
    v_mul_f32 v199, v199, v30
    v_mul_f32 v200, v200, v30
    v_mul_f32 v201, v201, v30
    v_mul_f32 v202, v202, v30
    v_mul_f32 v203, v203, v30
    v_mul_f32 v204, v204, v30
    v_mul_f32 v205, v205, v30
    v_mul_f32 v206, v206, v30
    v_mul_f32 v207, v207, v30
    v_mul_f32 v208, v208, v30
    v_mul_f32 v209, v209, v30
    v_mul_f32 v210, v210, v30
    v_mul_f32 v211, v211, v30
    v_mul_f32 v212, v212, v30
    v_mul_f32 v213, v213, v30
    v_mul_f32 v214, v214, v30
    v_mul_f32 v215, v215, v30
    v_mul_f32 v216, v216, v30
    v_mul_f32 v217, v217, v30
    v_mul_f32 v218, v218, v30
    v_mul_f32 v219, v219, v30
    v_mul_f32 v220, v220, v30
    v_mul_f32 v221, v221, v30
    v_mul_f32 v222, v222, v30
    v_mul_f32 v223, v223, v30
    v_mul_f32 v224, v224, v30
    v_mul_f32 v225, v225, v30
    v_mul_f32 v226, v226, v30
    v_mul_f32 v227, v227, v30
    v_mul_f32 v228, v228, v30
    v_mul_f32 v229, v229, v30
    v_mul_f32 v230, v230, v30
    v_mul_f32 v231, v231, v30
    v_mul_f32 v232, v232, v30
    v_mul_f32 v233, v233, v30
    v_mul_f32 v234, v234, v30
    v_mul_f32 v235, v235, v30
    v_mul_f32 v236, v236, v30
    v_mul_f32 v237, v237, v30
    v_mul_f32 v238, v238, v30
    v_mul_f32 v239, v239, v30
    v_mul_f32 v240, v240, v30
    v_mul_f32 v241, v241, v30
    v_mul_f32 v242, v242, v30
    v_mul_f32 v243, v243, v30
    v_mul_f32 v244, v244, v30
    v_mul_f32 v245, v245, v30
    v_mul_f32 v246, v246, v30
    v_mul_f32 v247, v247, v30
    v_mul_f32 v248, v248, v30
    v_mul_f32 v249, v249, v30
    v_mul_f32 v250, v250, v30
    v_mul_f32 v251, v251, v30
    v_mul_f32 v252, v252, v30
    v_mul_f32 v253, v253, v30
    v_mul_f32 v254, v254, v30
    v_mul_f32 v255, v255, v30
    s_mov_b32 s68, 0
    s_nop 4
    s_branch L_back2_25
L_rare1_26:
    s_nop 4
    v_mov_b32 v29, v28
    s_nop 2
    v_permlane32_swap_b32 v29, v28
    s_nop 2
    v_max_f32 v28, v28, v29
    v_max_f32 v28, 0, v28
    v_sub_f32 v30, 0, v28
    v_exp_f32 v30, v30
    v_add_f32 v24, v24, v28
    s_nop 15
    v_sub_f32 v32, 0, v24
    v_sub_f32 v33, 0, v24
    v_sub_f32 v34, 0, v24
    v_sub_f32 v35, 0, v24
    v_sub_f32 v36, 0, v24
    v_sub_f32 v37, 0, v24
    v_sub_f32 v38, 0, v24
    v_sub_f32 v39, 0, v24
    v_sub_f32 v40, 0, v24
    v_sub_f32 v41, 0, v24
    v_sub_f32 v42, 0, v24
    v_sub_f32 v43, 0, v24
    v_sub_f32 v44, 0, v24
    v_sub_f32 v45, 0, v24
    v_sub_f32 v46, 0, v24
    v_sub_f32 v47, 0, v24
    v_sub_f32 v80, v80, v28
    v_sub_f32 v81, v81, v28
    v_sub_f32 v82, v82, v28
    v_sub_f32 v83, v83, v28
    v_sub_f32 v84, v84, v28
    v_sub_f32 v85, v85, v28
    v_sub_f32 v86, v86, v28
    v_sub_f32 v87, v87, v28
    v_sub_f32 v88, v88, v28
    v_sub_f32 v89, v89, v28
    v_sub_f32 v90, v90, v28
    v_sub_f32 v91, v91, v28
    v_sub_f32 v92, v92, v28
    v_sub_f32 v93, v93, v28
    v_sub_f32 v94, v94, v28
    v_sub_f32 v95, v95, v28
    v_mul_f32 v26, v26, v30
    v_mul_f32 v27, v27, v30
    s_mov_b32 s68, 1
    s_nop 4
    s_branch L_back1_27
L_rare2_28:
    s_nop 15
    v_mul_f32 v192, v192, v30
    v_mul_f32 v193, v193, v30
    v_mul_f32 v194, v194, v30
    v_mul_f32 v195, v195, v30
    v_mul_f32 v196, v196, v30
    v_mul_f32 v197, v197, v30
    v_mul_f32 v198, v198, v30
    v_mul_f32 v199, v199, v30
    v_mul_f32 v200, v200, v30
    v_mul_f32 v201, v201, v30
    v_mul_f32 v202, v202, v30
    v_mul_f32 v203, v203, v30
    v_mul_f32 v204, v204, v30
    v_mul_f32 v205, v205, v30
    v_mul_f32 v206, v206, v30
    v_mul_f32 v207, v207, v30
    v_mul_f32 v208, v208, v30
    v_mul_f32 v209, v209, v30
    v_mul_f32 v210, v210, v30
    v_mul_f32 v211, v211, v30
    v_mul_f32 v212, v212, v30
    v_mul_f32 v213, v213, v30
    v_mul_f32 v214, v214, v30
    v_mul_f32 v215, v215, v30
    v_mul_f32 v216, v216, v30
    v_mul_f32 v217, v217, v30
    v_mul_f32 v218, v218, v30
    v_mul_f32 v219, v219, v30
    v_mul_f32 v220, v220, v30
    v_mul_f32 v221, v221, v30
    v_mul_f32 v222, v222, v30
    v_mul_f32 v223, v223, v30
    v_mul_f32 v224, v224, v30
    v_mul_f32 v225, v225, v30
    v_mul_f32 v226, v226, v30
    v_mul_f32 v227, v227, v30
    v_mul_f32 v228, v228, v30
    v_mul_f32 v229, v229, v30
    v_mul_f32 v230, v230, v30
    v_mul_f32 v231, v231, v30
    v_mul_f32 v232, v232, v30
    v_mul_f32 v233, v233, v30
    v_mul_f32 v234, v234, v30
    v_mul_f32 v235, v235, v30
    v_mul_f32 v236, v236, v30
    v_mul_f32 v237, v237, v30
    v_mul_f32 v238, v238, v30
    v_mul_f32 v239, v239, v30
    v_mul_f32 v240, v240, v30
    v_mul_f32 v241, v241, v30
    v_mul_f32 v242, v242, v30
    v_mul_f32 v243, v243, v30
    v_mul_f32 v244, v244, v30
    v_mul_f32 v245, v245, v30
    v_mul_f32 v246, v246, v30
    v_mul_f32 v247, v247, v30
    v_mul_f32 v248, v248, v30
    v_mul_f32 v249, v249, v30
    v_mul_f32 v250, v250, v30
    v_mul_f32 v251, v251, v30
    v_mul_f32 v252, v252, v30
    v_mul_f32 v253, v253, v30
    v_mul_f32 v254, v254, v30
    v_mul_f32 v255, v255, v30
    s_mov_b32 s68, 0
    s_nop 4
    s_branch L_back2_29
L_rare1_30:
    s_nop 4
    v_mov_b32 v29, v28
    s_nop 2
    v_permlane32_swap_b32 v29, v28
    s_nop 2
    v_max_f32 v28, v28, v29
    v_max_f32 v28, 0, v28
    v_sub_f32 v30, 0, v28
    v_exp_f32 v30, v30
    v_add_f32 v24, v24, v28
    s_nop 15
    v_sub_f32 v32, 0, v24
    v_sub_f32 v33, 0, v24
    v_sub_f32 v34, 0, v24
    v_sub_f32 v35, 0, v24
    v_sub_f32 v36, 0, v24
    v_sub_f32 v37, 0, v24
    v_sub_f32 v38, 0, v24
    v_sub_f32 v39, 0, v24
    v_sub_f32 v40, 0, v24
    v_sub_f32 v41, 0, v24
    v_sub_f32 v42, 0, v24
    v_sub_f32 v43, 0, v24
    v_sub_f32 v44, 0, v24
    v_sub_f32 v45, 0, v24
    v_sub_f32 v46, 0, v24
    v_sub_f32 v47, 0, v24
    v_sub_f32 v64, v64, v28
    v_sub_f32 v65, v65, v28
    v_sub_f32 v66, v66, v28
    v_sub_f32 v67, v67, v28
    v_sub_f32 v68, v68, v28
    v_sub_f32 v69, v69, v28
    v_sub_f32 v70, v70, v28
    v_sub_f32 v71, v71, v28
    v_sub_f32 v72, v72, v28
    v_sub_f32 v73, v73, v28
    v_sub_f32 v74, v74, v28
    v_sub_f32 v75, v75, v28
    v_sub_f32 v76, v76, v28
    v_sub_f32 v77, v77, v28
    v_sub_f32 v78, v78, v28
    v_sub_f32 v79, v79, v28
    v_mul_f32 v26, v26, v30
    v_mul_f32 v27, v27, v30
    s_mov_b32 s68, 1
    s_nop 4
    s_branch L_back1_31
L_rare2_32:
    s_nop 15
    v_mul_f32 v192, v192, v30
    v_mul_f32 v193, v193, v30
    v_mul_f32 v194, v194, v30
    v_mul_f32 v195, v195, v30
    v_mul_f32 v196, v196, v30
    v_mul_f32 v197, v197, v30
    v_mul_f32 v198, v198, v30
    v_mul_f32 v199, v199, v30
    v_mul_f32 v200, v200, v30
    v_mul_f32 v201, v201, v30
    v_mul_f32 v202, v202, v30
    v_mul_f32 v203, v203, v30
    v_mul_f32 v204, v204, v30
    v_mul_f32 v205, v205, v30
    v_mul_f32 v206, v206, v30
    v_mul_f32 v207, v207, v30
    v_mul_f32 v208, v208, v30
    v_mul_f32 v209, v209, v30
    v_mul_f32 v210, v210, v30
    v_mul_f32 v211, v211, v30
    v_mul_f32 v212, v212, v30
    v_mul_f32 v213, v213, v30
    v_mul_f32 v214, v214, v30
    v_mul_f32 v215, v215, v30
    v_mul_f32 v216, v216, v30
    v_mul_f32 v217, v217, v30
    v_mul_f32 v218, v218, v30
    v_mul_f32 v219, v219, v30
    v_mul_f32 v220, v220, v30
    v_mul_f32 v221, v221, v30
    v_mul_f32 v222, v222, v30
    v_mul_f32 v223, v223, v30
    v_mul_f32 v224, v224, v30
    v_mul_f32 v225, v225, v30
    v_mul_f32 v226, v226, v30
    v_mul_f32 v227, v227, v30
    v_mul_f32 v228, v228, v30
    v_mul_f32 v229, v229, v30
    v_mul_f32 v230, v230, v30
    v_mul_f32 v231, v231, v30
    v_mul_f32 v232, v232, v30
    v_mul_f32 v233, v233, v30
    v_mul_f32 v234, v234, v30
    v_mul_f32 v235, v235, v30
    v_mul_f32 v236, v236, v30
    v_mul_f32 v237, v237, v30
    v_mul_f32 v238, v238, v30
    v_mul_f32 v239, v239, v30
    v_mul_f32 v240, v240, v30
    v_mul_f32 v241, v241, v30
    v_mul_f32 v242, v242, v30
    v_mul_f32 v243, v243, v30
    v_mul_f32 v244, v244, v30
    v_mul_f32 v245, v245, v30
    v_mul_f32 v246, v246, v30
    v_mul_f32 v247, v247, v30
    v_mul_f32 v248, v248, v30
    v_mul_f32 v249, v249, v30
    v_mul_f32 v250, v250, v30
    v_mul_f32 v251, v251, v30
    v_mul_f32 v252, v252, v30
    v_mul_f32 v253, v253, v30
    v_mul_f32 v254, v254, v30
    v_mul_f32 v255, v255, v30
    s_mov_b32 s68, 0
    s_nop 4
    s_branch L_back2_33
L_rare1_34:
    s_nop 4
    v_mov_b32 v29, v28
    s_nop 2
    v_permlane32_swap_b32 v29, v28
    s_nop 2
    v_max_f32 v28, v28, v29
    v_max_f32 v28, 0, v28
    v_sub_f32 v30, 0, v28
    v_exp_f32 v30, v30
    v_add_f32 v24, v24, v28
    s_nop 15
    v_sub_f32 v32, 0, v24
    v_sub_f32 v33, 0, v24
    v_sub_f32 v34, 0, v24
    v_sub_f32 v35, 0, v24
    v_sub_f32 v36, 0, v24
    v_sub_f32 v37, 0, v24
    v_sub_f32 v38, 0, v24
    v_sub_f32 v39, 0, v24
    v_sub_f32 v40, 0, v24
    v_sub_f32 v41, 0, v24
    v_sub_f32 v42, 0, v24
    v_sub_f32 v43, 0, v24
    v_sub_f32 v44, 0, v24
    v_sub_f32 v45, 0, v24
    v_sub_f32 v46, 0, v24
    v_sub_f32 v47, 0, v24
    v_sub_f32 v80, v80, v28
    v_sub_f32 v81, v81, v28
    v_sub_f32 v82, v82, v28
    v_sub_f32 v83, v83, v28
    v_sub_f32 v84, v84, v28
    v_sub_f32 v85, v85, v28
    v_sub_f32 v86, v86, v28
    v_sub_f32 v87, v87, v28
    v_sub_f32 v88, v88, v28
    v_sub_f32 v89, v89, v28
    v_sub_f32 v90, v90, v28
    v_sub_f32 v91, v91, v28
    v_sub_f32 v92, v92, v28
    v_sub_f32 v93, v93, v28
    v_sub_f32 v94, v94, v28
    v_sub_f32 v95, v95, v28
    v_mul_f32 v26, v26, v30
    v_mul_f32 v27, v27, v30
    s_mov_b32 s68, 1
    s_nop 4
    s_branch L_back1_35
L_rare2_36:
    s_nop 15
    v_mul_f32 v192, v192, v30
    v_mul_f32 v193, v193, v30
    v_mul_f32 v194, v194, v30
    v_mul_f32 v195, v195, v30
    v_mul_f32 v196, v196, v30
    v_mul_f32 v197, v197, v30
    v_mul_f32 v198, v198, v30
    v_mul_f32 v199, v199, v30
    v_mul_f32 v200, v200, v30
    v_mul_f32 v201, v201, v30
    v_mul_f32 v202, v202, v30
    v_mul_f32 v203, v203, v30
    v_mul_f32 v204, v204, v30
    v_mul_f32 v205, v205, v30
    v_mul_f32 v206, v206, v30
    v_mul_f32 v207, v207, v30
    v_mul_f32 v208, v208, v30
    v_mul_f32 v209, v209, v30
    v_mul_f32 v210, v210, v30
    v_mul_f32 v211, v211, v30
    v_mul_f32 v212, v212, v30
    v_mul_f32 v213, v213, v30
    v_mul_f32 v214, v214, v30
    v_mul_f32 v215, v215, v30
    v_mul_f32 v216, v216, v30
    v_mul_f32 v217, v217, v30
    v_mul_f32 v218, v218, v30
    v_mul_f32 v219, v219, v30
    v_mul_f32 v220, v220, v30
    v_mul_f32 v221, v221, v30
    v_mul_f32 v222, v222, v30
    v_mul_f32 v223, v223, v30
    v_mul_f32 v224, v224, v30
    v_mul_f32 v225, v225, v30
    v_mul_f32 v226, v226, v30
    v_mul_f32 v227, v227, v30
    v_mul_f32 v228, v228, v30
    v_mul_f32 v229, v229, v30
    v_mul_f32 v230, v230, v30
    v_mul_f32 v231, v231, v30
    v_mul_f32 v232, v232, v30
    v_mul_f32 v233, v233, v30
    v_mul_f32 v234, v234, v30
    v_mul_f32 v235, v235, v30
    v_mul_f32 v236, v236, v30
    v_mul_f32 v237, v237, v30
    v_mul_f32 v238, v238, v30
    v_mul_f32 v239, v239, v30
    v_mul_f32 v240, v240, v30
    v_mul_f32 v241, v241, v30
    v_mul_f32 v242, v242, v30
    v_mul_f32 v243, v243, v30
    v_mul_f32 v244, v244, v30
    v_mul_f32 v245, v245, v30
    v_mul_f32 v246, v246, v30
    v_mul_f32 v247, v247, v30
    v_mul_f32 v248, v248, v30
    v_mul_f32 v249, v249, v30
    v_mul_f32 v250, v250, v30
    v_mul_f32 v251, v251, v30
    v_mul_f32 v252, v252, v30
    v_mul_f32 v253, v253, v30
    v_mul_f32 v254, v254, v30
    v_mul_f32 v255, v255, v30
    s_mov_b32 s68, 0
    s_nop 4
    s_branch L_back2_37
L_rare1_40:
    s_nop 4
    v_mov_b32 v29, v28
    s_nop 2
    v_permlane32_swap_b32 v29, v28
    s_nop 2
    v_max_f32 v28, v28, v29
    v_max_f32 v28, 0, v28
    v_sub_f32 v30, 0, v28
    v_exp_f32 v30, v30
    v_add_f32 v24, v24, v28
    s_nop 15
    v_sub_f32 v32, 0, v24
    v_sub_f32 v33, 0, v24
    v_sub_f32 v34, 0, v24
    v_sub_f32 v35, 0, v24
    v_sub_f32 v36, 0, v24
    v_sub_f32 v37, 0, v24
    v_sub_f32 v38, 0, v24
    v_sub_f32 v39, 0, v24
    v_sub_f32 v40, 0, v24
    v_sub_f32 v41, 0, v24
    v_sub_f32 v42, 0, v24
    v_sub_f32 v43, 0, v24
    v_sub_f32 v44, 0, v24
    v_sub_f32 v45, 0, v24
    v_sub_f32 v46, 0, v24
    v_sub_f32 v47, 0, v24
    v_sub_f32 v64, v64, v28
    v_sub_f32 v65, v65, v28
    v_sub_f32 v66, v66, v28
    v_sub_f32 v67, v67, v28
    v_sub_f32 v68, v68, v28
    v_sub_f32 v69, v69, v28
    v_sub_f32 v70, v70, v28
    v_sub_f32 v71, v71, v28
    v_sub_f32 v72, v72, v28
    v_sub_f32 v73, v73, v28
    v_sub_f32 v74, v74, v28
    v_sub_f32 v75, v75, v28
    v_sub_f32 v76, v76, v28
    v_sub_f32 v77, v77, v28
    v_sub_f32 v78, v78, v28
    v_sub_f32 v79, v79, v28
    v_mul_f32 v26, v26, v30
    v_mul_f32 v27, v27, v30
    v_mul_f32 v192, v192, v30
    v_mul_f32 v193, v193, v30
    v_mul_f32 v194, v194, v30
    v_mul_f32 v195, v195, v30
    v_mul_f32 v196, v196, v30
    v_mul_f32 v197, v197, v30
    v_mul_f32 v198, v198, v30
    v_mul_f32 v199, v199, v30
    v_mul_f32 v200, v200, v30
    v_mul_f32 v201, v201, v30
    v_mul_f32 v202, v202, v30
    v_mul_f32 v203, v203, v30
    v_mul_f32 v204, v204, v30
    v_mul_f32 v205, v205, v30
    v_mul_f32 v206, v206, v30
    v_mul_f32 v207, v207, v30
    v_mul_f32 v208, v208, v30
    v_mul_f32 v209, v209, v30
    v_mul_f32 v210, v210, v30
    v_mul_f32 v211, v211, v30
    v_mul_f32 v212, v212, v30
    v_mul_f32 v213, v213, v30
    v_mul_f32 v214, v214, v30
    v_mul_f32 v215, v215, v30
    v_mul_f32 v216, v216, v30
    v_mul_f32 v217, v217, v30
    v_mul_f32 v218, v218, v30
    v_mul_f32 v219, v219, v30
    v_mul_f32 v220, v220, v30
    v_mul_f32 v221, v221, v30
    v_mul_f32 v222, v222, v30
    v_mul_f32 v223, v223, v30
    v_mul_f32 v224, v224, v30
    v_mul_f32 v225, v225, v30
    v_mul_f32 v226, v226, v30
    v_mul_f32 v227, v227, v30
    v_mul_f32 v228, v228, v30
    v_mul_f32 v229, v229, v30
    v_mul_f32 v230, v230, v30
    v_mul_f32 v231, v231, v30
    v_mul_f32 v232, v232, v30
    v_mul_f32 v233, v233, v30
    v_mul_f32 v234, v234, v30
    v_mul_f32 v235, v235, v30
    v_mul_f32 v236, v236, v30
    v_mul_f32 v237, v237, v30
    v_mul_f32 v238, v238, v30
    v_mul_f32 v239, v239, v30
    v_mul_f32 v240, v240, v30
    v_mul_f32 v241, v241, v30
    v_mul_f32 v242, v242, v30
    v_mul_f32 v243, v243, v30
    v_mul_f32 v244, v244, v30
    v_mul_f32 v245, v245, v30
    v_mul_f32 v246, v246, v30
    v_mul_f32 v247, v247, v30
    v_mul_f32 v248, v248, v30
    v_mul_f32 v249, v249, v30
    v_mul_f32 v250, v250, v30
    v_mul_f32 v251, v251, v30
    v_mul_f32 v252, v252, v30
    v_mul_f32 v253, v253, v30
    v_mul_f32 v254, v254, v30
    v_mul_f32 v255, v255, v30
    v_lshlrev_b32 v28, 16, v56
    v_and_b32 v29, 0xffff0000, v56
    v_mul_f32 v28, v28, v30
    v_mul_f32 v29, v29, v30
    v_cvt_pk_bf16_f32 v56, v28, v29
    v_lshlrev_b32 v28, 16, v57
    v_and_b32 v29, 0xffff0000, v57
    v_mul_f32 v28, v28, v30
    v_mul_f32 v29, v29, v30
    v_cvt_pk_bf16_f32 v57, v28, v29
    v_lshlrev_b32 v28, 16, v58
    v_and_b32 v29, 0xffff0000, v58
    v_mul_f32 v28, v28, v30
    v_mul_f32 v29, v29, v30
    v_cvt_pk_bf16_f32 v58, v28, v29
    v_lshlrev_b32 v28, 16, v59
    v_and_b32 v29, 0xffff0000, v59
    v_mul_f32 v28, v28, v30
    v_mul_f32 v29, v29, v30
    v_cvt_pk_bf16_f32 v59, v28, v29
    v_lshlrev_b32 v28, 16, v60
    v_and_b32 v29, 0xffff0000, v60
    v_mul_f32 v28, v28, v30
    v_mul_f32 v29, v29, v30
    v_cvt_pk_bf16_f32 v60, v28, v29
    v_lshlrev_b32 v28, 16, v61
    v_and_b32 v29, 0xffff0000, v61
    v_mul_f32 v28, v28, v30
    v_mul_f32 v29, v29, v30
    v_cvt_pk_bf16_f32 v61, v28, v29
    v_lshlrev_b32 v28, 16, v62
    v_and_b32 v29, 0xffff0000, v62
    v_mul_f32 v28, v28, v30
    v_mul_f32 v29, v29, v30
    v_cvt_pk_bf16_f32 v62, v28, v29
    v_lshlrev_b32 v28, 16, v63
    v_and_b32 v29, 0xffff0000, v63
    v_mul_f32 v28, v28, v30
    v_mul_f32 v29, v29, v30
    v_cvt_pk_bf16_f32 v63, v28, v29
    s_nop 4
    s_branch L_back1_41
L_rare1_42:
    s_nop 4
    v_mov_b32 v29, v28
    s_nop 2
    v_permlane32_swap_b32 v29, v28
    s_nop 2
    v_max_f32 v28, v28, v29
    v_max_f32 v28, 0, v28
    v_sub_f32 v30, 0, v28
    v_exp_f32 v30, v30
    v_add_f32 v24, v24, v28
    s_nop 15
    v_sub_f32 v32, 0, v24
    v_sub_f32 v33, 0, v24
    v_sub_f32 v34, 0, v24
    v_sub_f32 v35, 0, v24
    v_sub_f32 v36, 0, v24
    v_sub_f32 v37, 0, v24
    v_sub_f32 v38, 0, v24
    v_sub_f32 v39, 0, v24
    v_sub_f32 v40, 0, v24
    v_sub_f32 v41, 0, v24
    v_sub_f32 v42, 0, v24
    v_sub_f32 v43, 0, v24
    v_sub_f32 v44, 0, v24
    v_sub_f32 v45, 0, v24
    v_sub_f32 v46, 0, v24
    v_sub_f32 v47, 0, v24
    v_sub_f32 v80, v80, v28
    v_sub_f32 v81, v81, v28
    v_sub_f32 v82, v82, v28
    v_sub_f32 v83, v83, v28
    v_sub_f32 v84, v84, v28
    v_sub_f32 v85, v85, v28
    v_sub_f32 v86, v86, v28
    v_sub_f32 v87, v87, v28
    v_sub_f32 v88, v88, v28
    v_sub_f32 v89, v89, v28
    v_sub_f32 v90, v90, v28
    v_sub_f32 v91, v91, v28
    v_sub_f32 v92, v92, v28
    v_sub_f32 v93, v93, v28
    v_sub_f32 v94, v94, v28
    v_sub_f32 v95, v95, v28
    v_mul_f32 v26, v26, v30
    v_mul_f32 v27, v27, v30
    v_mul_f32 v192, v192, v30
    v_mul_f32 v193, v193, v30
    v_mul_f32 v194, v194, v30
    v_mul_f32 v195, v195, v30
    v_mul_f32 v196, v196, v30
    v_mul_f32 v197, v197, v30
    v_mul_f32 v198, v198, v30
    v_mul_f32 v199, v199, v30
    v_mul_f32 v200, v200, v30
    v_mul_f32 v201, v201, v30
    v_mul_f32 v202, v202, v30
    v_mul_f32 v203, v203, v30
    v_mul_f32 v204, v204, v30
    v_mul_f32 v205, v205, v30
    v_mul_f32 v206, v206, v30
    v_mul_f32 v207, v207, v30
    v_mul_f32 v208, v208, v30
    v_mul_f32 v209, v209, v30
    v_mul_f32 v210, v210, v30
    v_mul_f32 v211, v211, v30
    v_mul_f32 v212, v212, v30
    v_mul_f32 v213, v213, v30
    v_mul_f32 v214, v214, v30
    v_mul_f32 v215, v215, v30
    v_mul_f32 v216, v216, v30
    v_mul_f32 v217, v217, v30
    v_mul_f32 v218, v218, v30
    v_mul_f32 v219, v219, v30
    v_mul_f32 v220, v220, v30
    v_mul_f32 v221, v221, v30
    v_mul_f32 v222, v222, v30
    v_mul_f32 v223, v223, v30
    v_mul_f32 v224, v224, v30
    v_mul_f32 v225, v225, v30
    v_mul_f32 v226, v226, v30
    v_mul_f32 v227, v227, v30
    v_mul_f32 v228, v228, v30
    v_mul_f32 v229, v229, v30
    v_mul_f32 v230, v230, v30
    v_mul_f32 v231, v231, v30
    v_mul_f32 v232, v232, v30
    v_mul_f32 v233, v233, v30
    v_mul_f32 v234, v234, v30
    v_mul_f32 v235, v235, v30
    v_mul_f32 v236, v236, v30
    v_mul_f32 v237, v237, v30
    v_mul_f32 v238, v238, v30
    v_mul_f32 v239, v239, v30
    v_mul_f32 v240, v240, v30
    v_mul_f32 v241, v241, v30
    v_mul_f32 v242, v242, v30
    v_mul_f32 v243, v243, v30
    v_mul_f32 v244, v244, v30
    v_mul_f32 v245, v245, v30
    v_mul_f32 v246, v246, v30
    v_mul_f32 v247, v247, v30
    v_mul_f32 v248, v248, v30
    v_mul_f32 v249, v249, v30
    v_mul_f32 v250, v250, v30
    v_mul_f32 v251, v251, v30
    v_mul_f32 v252, v252, v30
    v_mul_f32 v253, v253, v30
    v_mul_f32 v254, v254, v30
    v_mul_f32 v255, v255, v30
    v_lshlrev_b32 v28, 16, v56
    v_and_b32 v29, 0xffff0000, v56
    v_mul_f32 v28, v28, v30
    v_mul_f32 v29, v29, v30
    v_cvt_pk_bf16_f32 v56, v28, v29
    v_lshlrev_b32 v28, 16, v57
    v_and_b32 v29, 0xffff0000, v57
    v_mul_f32 v28, v28, v30
    v_mul_f32 v29, v29, v30
    v_cvt_pk_bf16_f32 v57, v28, v29
    v_lshlrev_b32 v28, 16, v58
    v_and_b32 v29, 0xffff0000, v58
    v_mul_f32 v28, v28, v30
    v_mul_f32 v29, v29, v30
    v_cvt_pk_bf16_f32 v58, v28, v29
    v_lshlrev_b32 v28, 16, v59
    v_and_b32 v29, 0xffff0000, v59
    v_mul_f32 v28, v28, v30
    v_mul_f32 v29, v29, v30
    v_cvt_pk_bf16_f32 v59, v28, v29
    v_lshlrev_b32 v28, 16, v60
    v_and_b32 v29, 0xffff0000, v60
    v_mul_f32 v28, v28, v30
    v_mul_f32 v29, v29, v30
    v_cvt_pk_bf16_f32 v60, v28, v29
    v_lshlrev_b32 v28, 16, v61
    v_and_b32 v29, 0xffff0000, v61
    v_mul_f32 v28, v28, v30
    v_mul_f32 v29, v29, v30
    v_cvt_pk_bf16_f32 v61, v28, v29
    v_lshlrev_b32 v28, 16, v62
    v_and_b32 v29, 0xffff0000, v62
    v_mul_f32 v28, v28, v30
    v_mul_f32 v29, v29, v30
    v_cvt_pk_bf16_f32 v62, v28, v29
    v_lshlrev_b32 v28, 16, v63
    v_and_b32 v29, 0xffff0000, v63
    v_mul_f32 v28, v28, v30
    v_mul_f32 v29, v29, v30
    v_cvt_pk_bf16_f32 v63, v28, v29
    v_lshlrev_b32 v28, 16, v48
    v_and_b32 v29, 0xffff0000, v48
    v_mul_f32 v28, v28, v30
    v_mul_f32 v29, v29, v30
    v_cvt_pk_bf16_f32 v48, v28, v29
    v_lshlrev_b32 v28, 16, v49
    v_and_b32 v29, 0xffff0000, v49
    v_mul_f32 v28, v28, v30
    v_mul_f32 v29, v29, v30
    v_cvt_pk_bf16_f32 v49, v28, v29
    v_lshlrev_b32 v28, 16, v50
    v_and_b32 v29, 0xffff0000, v50
    v_mul_f32 v28, v28, v30
    v_mul_f32 v29, v29, v30
    v_cvt_pk_bf16_f32 v50, v28, v29
    v_lshlrev_b32 v28, 16, v51
    v_and_b32 v29, 0xffff0000, v51
    v_mul_f32 v28, v28, v30
    v_mul_f32 v29, v29, v30
    v_cvt_pk_bf16_f32 v51, v28, v29
    v_lshlrev_b32 v28, 16, v52
    v_and_b32 v29, 0xffff0000, v52
    v_mul_f32 v28, v28, v30
    v_mul_f32 v29, v29, v30
    v_cvt_pk_bf16_f32 v52, v28, v29
    v_lshlrev_b32 v28, 16, v53
    v_and_b32 v29, 0xffff0000, v53
    v_mul_f32 v28, v28, v30
    v_mul_f32 v29, v29, v30
    v_cvt_pk_bf16_f32 v53, v28, v29
    v_lshlrev_b32 v28, 16, v54
    v_and_b32 v29, 0xffff0000, v54
    v_mul_f32 v28, v28, v30
    v_mul_f32 v29, v29, v30
    v_cvt_pk_bf16_f32 v54, v28, v29
    v_lshlrev_b32 v28, 16, v55
    v_and_b32 v29, 0xffff0000, v55
    v_mul_f32 v28, v28, v30
    v_mul_f32 v29, v29, v30
    v_cvt_pk_bf16_f32 v55, v28, v29
    s_nop 4
    s_branch L_back1_43
L_rare1_44:
    s_nop 4
    v_mov_b32 v29, v28
    s_nop 2
    v_permlane32_swap_b32 v29, v28
    s_nop 2
    v_max_f32 v28, v28, v29
    v_max_f32 v28, 0, v28
    v_sub_f32 v30, 0, v28
    v_exp_f32 v30, v30
    v_add_f32 v24, v24, v28
    s_nop 15
    v_sub_f32 v32, 0, v24
    v_sub_f32 v33, 0, v24
    v_sub_f32 v34, 0, v24
    v_sub_f32 v35, 0, v24
    v_sub_f32 v36, 0, v24
    v_sub_f32 v37, 0, v24
    v_sub_f32 v38, 0, v24
    v_sub_f32 v39, 0, v24
    v_sub_f32 v40, 0, v24
    v_sub_f32 v41, 0, v24
    v_sub_f32 v42, 0, v24
    v_sub_f32 v43, 0, v24
    v_sub_f32 v44, 0, v24
    v_sub_f32 v45, 0, v24
    v_sub_f32 v46, 0, v24
    v_sub_f32 v47, 0, v24
    v_sub_f32 v64, v64, v28
    v_sub_f32 v65, v65, v28
    v_sub_f32 v66, v66, v28
    v_sub_f32 v67, v67, v28
    v_sub_f32 v68, v68, v28
    v_sub_f32 v69, v69, v28
    v_sub_f32 v70, v70, v28
    v_sub_f32 v71, v71, v28
    v_sub_f32 v72, v72, v28
    v_sub_f32 v73, v73, v28
    v_sub_f32 v74, v74, v28
    v_sub_f32 v75, v75, v28
    v_sub_f32 v76, v76, v28
    v_sub_f32 v77, v77, v28
    v_sub_f32 v78, v78, v28
    v_sub_f32 v79, v79, v28
    v_mul_f32 v26, v26, v30
    v_mul_f32 v27, v27, v30
    v_mul_f32 v192, v192, v30
    v_mul_f32 v193, v193, v30
    v_mul_f32 v194, v194, v30
    v_mul_f32 v195, v195, v30
    v_mul_f32 v196, v196, v30
    v_mul_f32 v197, v197, v30
    v_mul_f32 v198, v198, v30
    v_mul_f32 v199, v199, v30
    v_mul_f32 v200, v200, v30
    v_mul_f32 v201, v201, v30
    v_mul_f32 v202, v202, v30
    v_mul_f32 v203, v203, v30
    v_mul_f32 v204, v204, v30
    v_mul_f32 v205, v205, v30
    v_mul_f32 v206, v206, v30
    v_mul_f32 v207, v207, v30
    v_mul_f32 v208, v208, v30
    v_mul_f32 v209, v209, v30
    v_mul_f32 v210, v210, v30
    v_mul_f32 v211, v211, v30
    v_mul_f32 v212, v212, v30
    v_mul_f32 v213, v213, v30
    v_mul_f32 v214, v214, v30
    v_mul_f32 v215, v215, v30
    v_mul_f32 v216, v216, v30
    v_mul_f32 v217, v217, v30
    v_mul_f32 v218, v218, v30
    v_mul_f32 v219, v219, v30
    v_mul_f32 v220, v220, v30
    v_mul_f32 v221, v221, v30
    v_mul_f32 v222, v222, v30
    v_mul_f32 v223, v223, v30
    v_mul_f32 v224, v224, v30
    v_mul_f32 v225, v225, v30
    v_mul_f32 v226, v226, v30
    v_mul_f32 v227, v227, v30
    v_mul_f32 v228, v228, v30
    v_mul_f32 v229, v229, v30
    v_mul_f32 v230, v230, v30
    v_mul_f32 v231, v231, v30
    v_mul_f32 v232, v232, v30
    v_mul_f32 v233, v233, v30
    v_mul_f32 v234, v234, v30
    v_mul_f32 v235, v235, v30
    v_mul_f32 v236, v236, v30
    v_mul_f32 v237, v237, v30
    v_mul_f32 v238, v238, v30
    v_mul_f32 v239, v239, v30
    v_mul_f32 v240, v240, v30
    v_mul_f32 v241, v241, v30
    v_mul_f32 v242, v242, v30
    v_mul_f32 v243, v243, v30
    v_mul_f32 v244, v244, v30
    v_mul_f32 v245, v245, v30
    v_mul_f32 v246, v246, v30
    v_mul_f32 v247, v247, v30
    v_mul_f32 v248, v248, v30
    v_mul_f32 v249, v249, v30
    v_mul_f32 v250, v250, v30
    v_mul_f32 v251, v251, v30
    v_mul_f32 v252, v252, v30
    v_mul_f32 v253, v253, v30
    v_mul_f32 v254, v254, v30
    v_mul_f32 v255, v255, v30
    v_lshlrev_b32 v28, 16, v56
    v_and_b32 v29, 0xffff0000, v56
    v_mul_f32 v28, v28, v30
    v_mul_f32 v29, v29, v30
    v_cvt_pk_bf16_f32 v56, v28, v29
    v_lshlrev_b32 v28, 16, v57
    v_and_b32 v29, 0xffff0000, v57
    v_mul_f32 v28, v28, v30
    v_mul_f32 v29, v29, v30
    v_cvt_pk_bf16_f32 v57, v28, v29
    v_lshlrev_b32 v28, 16, v58
    v_and_b32 v29, 0xffff0000, v58
    v_mul_f32 v28, v28, v30
    v_mul_f32 v29, v29, v30
    v_cvt_pk_bf16_f32 v58, v28, v29
    v_lshlrev_b32 v28, 16, v59
    v_and_b32 v29, 0xffff0000, v59
    v_mul_f32 v28, v28, v30
    v_mul_f32 v29, v29, v30
    v_cvt_pk_bf16_f32 v59, v28, v29
    v_lshlrev_b32 v28, 16, v60
    v_and_b32 v29, 0xffff0000, v60
    v_mul_f32 v28, v28, v30
    v_mul_f32 v29, v29, v30
    v_cvt_pk_bf16_f32 v60, v28, v29
    v_lshlrev_b32 v28, 16, v61
    v_and_b32 v29, 0xffff0000, v61
    v_mul_f32 v28, v28, v30
    v_mul_f32 v29, v29, v30
    v_cvt_pk_bf16_f32 v61, v28, v29
    v_lshlrev_b32 v28, 16, v62
    v_and_b32 v29, 0xffff0000, v62
    v_mul_f32 v28, v28, v30
    v_mul_f32 v29, v29, v30
    v_cvt_pk_bf16_f32 v62, v28, v29
    v_lshlrev_b32 v28, 16, v63
    v_and_b32 v29, 0xffff0000, v63
    v_mul_f32 v28, v28, v30
    v_mul_f32 v29, v29, v30
    v_cvt_pk_bf16_f32 v63, v28, v29
    v_lshlrev_b32 v28, 16, v48
    v_and_b32 v29, 0xffff0000, v48
    v_mul_f32 v28, v28, v30
    v_mul_f32 v29, v29, v30
    v_cvt_pk_bf16_f32 v48, v28, v29
    v_lshlrev_b32 v28, 16, v49
    v_and_b32 v29, 0xffff0000, v49
    v_mul_f32 v28, v28, v30
    v_mul_f32 v29, v29, v30
    v_cvt_pk_bf16_f32 v49, v28, v29
    v_lshlrev_b32 v28, 16, v50
    v_and_b32 v29, 0xffff0000, v50
    v_mul_f32 v28, v28, v30
    v_mul_f32 v29, v29, v30
    v_cvt_pk_bf16_f32 v50, v28, v29
    v_lshlrev_b32 v28, 16, v51
    v_and_b32 v29, 0xffff0000, v51
    v_mul_f32 v28, v28, v30
    v_mul_f32 v29, v29, v30
    v_cvt_pk_bf16_f32 v51, v28, v29
    v_lshlrev_b32 v28, 16, v52
    v_and_b32 v29, 0xffff0000, v52
    v_mul_f32 v28, v28, v30
    v_mul_f32 v29, v29, v30
    v_cvt_pk_bf16_f32 v52, v28, v29
    v_lshlrev_b32 v28, 16, v53
    v_and_b32 v29, 0xffff0000, v53
    v_mul_f32 v28, v28, v30
    v_mul_f32 v29, v29, v30
    v_cvt_pk_bf16_f32 v53, v28, v29
    v_lshlrev_b32 v28, 16, v54
    v_and_b32 v29, 0xffff0000, v54
    v_mul_f32 v28, v28, v30
    v_mul_f32 v29, v29, v30
    v_cvt_pk_bf16_f32 v54, v28, v29
    v_lshlrev_b32 v28, 16, v55
    v_and_b32 v29, 0xffff0000, v55
    v_mul_f32 v28, v28, v30
    v_mul_f32 v29, v29, v30
    v_cvt_pk_bf16_f32 v55, v28, v29
    v_lshlrev_b32 v28, 16, v128
    v_and_b32 v29, 0xffff0000, v128
    v_mul_f32 v28, v28, v30
    v_mul_f32 v29, v29, v30
    v_cvt_pk_bf16_f32 v128, v28, v29
    v_lshlrev_b32 v28, 16, v129
    v_and_b32 v29, 0xffff0000, v129
    v_mul_f32 v28, v28, v30
    v_mul_f32 v29, v29, v30
    v_cvt_pk_bf16_f32 v129, v28, v29
    v_lshlrev_b32 v28, 16, v130
    v_and_b32 v29, 0xffff0000, v130
    v_mul_f32 v28, v28, v30
    v_mul_f32 v29, v29, v30
    v_cvt_pk_bf16_f32 v130, v28, v29
    v_lshlrev_b32 v28, 16, v131
    v_and_b32 v29, 0xffff0000, v131
    v_mul_f32 v28, v28, v30
    v_mul_f32 v29, v29, v30
    v_cvt_pk_bf16_f32 v131, v28, v29
    v_lshlrev_b32 v28, 16, v132
    v_and_b32 v29, 0xffff0000, v132
    v_mul_f32 v28, v28, v30
    v_mul_f32 v29, v29, v30
    v_cvt_pk_bf16_f32 v132, v28, v29
    v_lshlrev_b32 v28, 16, v133
    v_and_b32 v29, 0xffff0000, v133
    v_mul_f32 v28, v28, v30
    v_mul_f32 v29, v29, v30
    v_cvt_pk_bf16_f32 v133, v28, v29
    v_lshlrev_b32 v28, 16, v134
    v_and_b32 v29, 0xffff0000, v134
    v_mul_f32 v28, v28, v30
    v_mul_f32 v29, v29, v30
    v_cvt_pk_bf16_f32 v134, v28, v29
    v_lshlrev_b32 v28, 16, v135
    v_and_b32 v29, 0xffff0000, v135
    v_mul_f32 v28, v28, v30
    v_mul_f32 v29, v29, v30
    v_cvt_pk_bf16_f32 v135, v28, v29
    s_nop 4
    s_branch L_back1_45
L_rare1_46:
    s_nop 4
    v_mov_b32 v29, v28
    s_nop 2
    v_permlane32_swap_b32 v29, v28
    s_nop 2
    v_max_f32 v28, v28, v29
    v_max_f32 v28, 0, v28
    v_sub_f32 v30, 0, v28
    v_exp_f32 v30, v30
    v_add_f32 v24, v24, v28
    s_nop 15
    v_sub_f32 v32, 0, v24
    v_sub_f32 v33, 0, v24
    v_sub_f32 v34, 0, v24
    v_sub_f32 v35, 0, v24
    v_sub_f32 v36, 0, v24
    v_sub_f32 v37, 0, v24
    v_sub_f32 v38, 0, v24
    v_sub_f32 v39, 0, v24
    v_sub_f32 v40, 0, v24
    v_sub_f32 v41, 0, v24
    v_sub_f32 v42, 0, v24
    v_sub_f32 v43, 0, v24
    v_sub_f32 v44, 0, v24
    v_sub_f32 v45, 0, v24
    v_sub_f32 v46, 0, v24
    v_sub_f32 v47, 0, v24
    v_sub_f32 v80, v80, v28
    v_sub_f32 v81, v81, v28
    v_sub_f32 v82, v82, v28
    v_sub_f32 v83, v83, v28
    v_sub_f32 v84, v84, v28
    v_sub_f32 v85, v85, v28
    v_sub_f32 v86, v86, v28
    v_sub_f32 v87, v87, v28
    v_sub_f32 v88, v88, v28
    v_sub_f32 v89, v89, v28
    v_sub_f32 v90, v90, v28
    v_sub_f32 v91, v91, v28
    v_sub_f32 v92, v92, v28
    v_sub_f32 v93, v93, v28
    v_sub_f32 v94, v94, v28
    v_sub_f32 v95, v95, v28
    v_mul_f32 v26, v26, v30
    v_mul_f32 v27, v27, v30
    v_mul_f32 v192, v192, v30
    v_mul_f32 v193, v193, v30
    v_mul_f32 v194, v194, v30
    v_mul_f32 v195, v195, v30
    v_mul_f32 v196, v196, v30
    v_mul_f32 v197, v197, v30
    v_mul_f32 v198, v198, v30
    v_mul_f32 v199, v199, v30
    v_mul_f32 v200, v200, v30
    v_mul_f32 v201, v201, v30
    v_mul_f32 v202, v202, v30
    v_mul_f32 v203, v203, v30
    v_mul_f32 v204, v204, v30
    v_mul_f32 v205, v205, v30
    v_mul_f32 v206, v206, v30
    v_mul_f32 v207, v207, v30
    v_mul_f32 v208, v208, v30
    v_mul_f32 v209, v209, v30
    v_mul_f32 v210, v210, v30
    v_mul_f32 v211, v211, v30
    v_mul_f32 v212, v212, v30
    v_mul_f32 v213, v213, v30
    v_mul_f32 v214, v214, v30
    v_mul_f32 v215, v215, v30
    v_mul_f32 v216, v216, v30
    v_mul_f32 v217, v217, v30
    v_mul_f32 v218, v218, v30
    v_mul_f32 v219, v219, v30
    v_mul_f32 v220, v220, v30
    v_mul_f32 v221, v221, v30
    v_mul_f32 v222, v222, v30
    v_mul_f32 v223, v223, v30
    v_mul_f32 v224, v224, v30
    v_mul_f32 v225, v225, v30
    v_mul_f32 v226, v226, v30
    v_mul_f32 v227, v227, v30
    v_mul_f32 v228, v228, v30
    v_mul_f32 v229, v229, v30
    v_mul_f32 v230, v230, v30
    v_mul_f32 v231, v231, v30
    v_mul_f32 v232, v232, v30
    v_mul_f32 v233, v233, v30
    v_mul_f32 v234, v234, v30
    v_mul_f32 v235, v235, v30
    v_mul_f32 v236, v236, v30
    v_mul_f32 v237, v237, v30
    v_mul_f32 v238, v238, v30
    v_mul_f32 v239, v239, v30
    v_mul_f32 v240, v240, v30
    v_mul_f32 v241, v241, v30
    v_mul_f32 v242, v242, v30
    v_mul_f32 v243, v243, v30
    v_mul_f32 v244, v244, v30
    v_mul_f32 v245, v245, v30
    v_mul_f32 v246, v246, v30
    v_mul_f32 v247, v247, v30
    v_mul_f32 v248, v248, v30
    v_mul_f32 v249, v249, v30
    v_mul_f32 v250, v250, v30
    v_mul_f32 v251, v251, v30
    v_mul_f32 v252, v252, v30
    v_mul_f32 v253, v253, v30
    v_mul_f32 v254, v254, v30
    v_mul_f32 v255, v255, v30
    v_lshlrev_b32 v28, 16, v56
    v_and_b32 v29, 0xffff0000, v56
    v_mul_f32 v28, v28, v30
    v_mul_f32 v29, v29, v30
    v_cvt_pk_bf16_f32 v56, v28, v29
    v_lshlrev_b32 v28, 16, v57
    v_and_b32 v29, 0xffff0000, v57
    v_mul_f32 v28, v28, v30
    v_mul_f32 v29, v29, v30
    v_cvt_pk_bf16_f32 v57, v28, v29
    v_lshlrev_b32 v28, 16, v58
    v_and_b32 v29, 0xffff0000, v58
    v_mul_f32 v28, v28, v30
    v_mul_f32 v29, v29, v30
    v_cvt_pk_bf16_f32 v58, v28, v29
    v_lshlrev_b32 v28, 16, v59
    v_and_b32 v29, 0xffff0000, v59
    v_mul_f32 v28, v28, v30
    v_mul_f32 v29, v29, v30
    v_cvt_pk_bf16_f32 v59, v28, v29
    v_lshlrev_b32 v28, 16, v60
    v_and_b32 v29, 0xffff0000, v60
    v_mul_f32 v28, v28, v30
    v_mul_f32 v29, v29, v30
    v_cvt_pk_bf16_f32 v60, v28, v29
    v_lshlrev_b32 v28, 16, v61
    v_and_b32 v29, 0xffff0000, v61
    v_mul_f32 v28, v28, v30
    v_mul_f32 v29, v29, v30
    v_cvt_pk_bf16_f32 v61, v28, v29
    v_lshlrev_b32 v28, 16, v62
    v_and_b32 v29, 0xffff0000, v62
    v_mul_f32 v28, v28, v30
    v_mul_f32 v29, v29, v30
    v_cvt_pk_bf16_f32 v62, v28, v29
    v_lshlrev_b32 v28, 16, v63
    v_and_b32 v29, 0xffff0000, v63
    v_mul_f32 v28, v28, v30
    v_mul_f32 v29, v29, v30
    v_cvt_pk_bf16_f32 v63, v28, v29
    v_lshlrev_b32 v28, 16, v48
    v_and_b32 v29, 0xffff0000, v48
    v_mul_f32 v28, v28, v30
    v_mul_f32 v29, v29, v30
    v_cvt_pk_bf16_f32 v48, v28, v29
    v_lshlrev_b32 v28, 16, v49
    v_and_b32 v29, 0xffff0000, v49
    v_mul_f32 v28, v28, v30
    v_mul_f32 v29, v29, v30
    v_cvt_pk_bf16_f32 v49, v28, v29
    v_lshlrev_b32 v28, 16, v50
    v_and_b32 v29, 0xffff0000, v50
    v_mul_f32 v28, v28, v30
    v_mul_f32 v29, v29, v30
    v_cvt_pk_bf16_f32 v50, v28, v29
    v_lshlrev_b32 v28, 16, v51
    v_and_b32 v29, 0xffff0000, v51
    v_mul_f32 v28, v28, v30
    v_mul_f32 v29, v29, v30
    v_cvt_pk_bf16_f32 v51, v28, v29
    v_lshlrev_b32 v28, 16, v52
    v_and_b32 v29, 0xffff0000, v52
    v_mul_f32 v28, v28, v30
    v_mul_f32 v29, v29, v30
    v_cvt_pk_bf16_f32 v52, v28, v29
    v_lshlrev_b32 v28, 16, v53
    v_and_b32 v29, 0xffff0000, v53
    v_mul_f32 v28, v28, v30
    v_mul_f32 v29, v29, v30
    v_cvt_pk_bf16_f32 v53, v28, v29
    v_lshlrev_b32 v28, 16, v54
    v_and_b32 v29, 0xffff0000, v54
    v_mul_f32 v28, v28, v30
    v_mul_f32 v29, v29, v30
    v_cvt_pk_bf16_f32 v54, v28, v29
    v_lshlrev_b32 v28, 16, v55
    v_and_b32 v29, 0xffff0000, v55
    v_mul_f32 v28, v28, v30
    v_mul_f32 v29, v29, v30
    v_cvt_pk_bf16_f32 v55, v28, v29
    v_lshlrev_b32 v28, 16, v128
    v_and_b32 v29, 0xffff0000, v128
    v_mul_f32 v28, v28, v30
    v_mul_f32 v29, v29, v30
    v_cvt_pk_bf16_f32 v128, v28, v29
    v_lshlrev_b32 v28, 16, v129
    v_and_b32 v29, 0xffff0000, v129
    v_mul_f32 v28, v28, v30
    v_mul_f32 v29, v29, v30
    v_cvt_pk_bf16_f32 v129, v28, v29
    v_lshlrev_b32 v28, 16, v130
    v_and_b32 v29, 0xffff0000, v130
    v_mul_f32 v28, v28, v30
    v_mul_f32 v29, v29, v30
    v_cvt_pk_bf16_f32 v130, v28, v29
    v_lshlrev_b32 v28, 16, v131
    v_and_b32 v29, 0xffff0000, v131
    v_mul_f32 v28, v28, v30
    v_mul_f32 v29, v29, v30
    v_cvt_pk_bf16_f32 v131, v28, v29
    v_lshlrev_b32 v28, 16, v132
    v_and_b32 v29, 0xffff0000, v132
    v_mul_f32 v28, v28, v30
    v_mul_f32 v29, v29, v30
    v_cvt_pk_bf16_f32 v132, v28, v29
    v_lshlrev_b32 v28, 16, v133
    v_and_b32 v29, 0xffff0000, v133
    v_mul_f32 v28, v28, v30
    v_mul_f32 v29, v29, v30
    v_cvt_pk_bf16_f32 v133, v28, v29
    v_lshlrev_b32 v28, 16, v134
    v_and_b32 v29, 0xffff0000, v134
    v_mul_f32 v28, v28, v30
    v_mul_f32 v29, v29, v30
    v_cvt_pk_bf16_f32 v134, v28, v29
    v_lshlrev_b32 v28, 16, v135
    v_and_b32 v29, 0xffff0000, v135
    v_mul_f32 v28, v28, v30
    v_mul_f32 v29, v29, v30
    v_cvt_pk_bf16_f32 v135, v28, v29
    v_lshlrev_b32 v28, 16, v136
    v_and_b32 v29, 0xffff0000, v136
    v_mul_f32 v28, v28, v30
    v_mul_f32 v29, v29, v30
    v_cvt_pk_bf16_f32 v136, v28, v29
    v_lshlrev_b32 v28, 16, v137
    v_and_b32 v29, 0xffff0000, v137
    v_mul_f32 v28, v28, v30
    v_mul_f32 v29, v29, v30
    v_cvt_pk_bf16_f32 v137, v28, v29
    v_lshlrev_b32 v28, 16, v138
    v_and_b32 v29, 0xffff0000, v138
    v_mul_f32 v28, v28, v30
    v_mul_f32 v29, v29, v30
    v_cvt_pk_bf16_f32 v138, v28, v29
    v_lshlrev_b32 v28, 16, v139
    v_and_b32 v29, 0xffff0000, v139
    v_mul_f32 v28, v28, v30
    v_mul_f32 v29, v29, v30
    v_cvt_pk_bf16_f32 v139, v28, v29
    v_lshlrev_b32 v28, 16, v140
    v_and_b32 v29, 0xffff0000, v140
    v_mul_f32 v28, v28, v30
    v_mul_f32 v29, v29, v30
    v_cvt_pk_bf16_f32 v140, v28, v29
    v_lshlrev_b32 v28, 16, v141
    v_and_b32 v29, 0xffff0000, v141
    v_mul_f32 v28, v28, v30
    v_mul_f32 v29, v29, v30
    v_cvt_pk_bf16_f32 v141, v28, v29
    v_lshlrev_b32 v28, 16, v142
    v_and_b32 v29, 0xffff0000, v142
    v_mul_f32 v28, v28, v30
    v_mul_f32 v29, v29, v30
    v_cvt_pk_bf16_f32 v142, v28, v29
    v_lshlrev_b32 v28, 16, v143
    v_and_b32 v29, 0xffff0000, v143
    v_mul_f32 v28, v28, v30
    v_mul_f32 v29, v29, v30
    v_cvt_pk_bf16_f32 v143, v28, v29
    s_nop 4
    s_branch L_back1_47
L_exit:
    s_endpgm
.section .rodata,"a"
.p2align 6
.amdhsa_kernel standalone__sliding_block_cached__sampling_kernel
  .amdhsa_next_free_vgpr 256
  .amdhsa_next_free_sgpr 102
  .amdhsa_accum_offset 256
  .amdhsa_group_segment_fixed_size 0
  .amdhsa_kernarg_size 64
  .amdhsa_user_sgpr_count 2
  .amdhsa_user_sgpr_kernarg_segment_ptr 1
  .amdhsa_system_sgpr_workgroup_id_x 1
.end_amdhsa_kernel
```
